```python
import torch

def _softmax(x, axis=-1):
    return torch.softmax(x, dim=axis)

def _gelu(x):
    return torch.nn.functional.gelu(x, approximate='tanh')

def _silu(x):
    return torch.nn.functional.silu(x)

def _sigmoid(x):
    return torch.sigmoid(x)

def _layernorm(x, axis=-1, eps=1e-05):
    m = x.mean(dim=axis, keepdim=True)
    v = x.var(dim=axis, keepdim=True, unbiased=False)
    return (x - m) / torch.sqrt(v + eps)

def _scatter_add(tgt, idx, src, axis=0):
    return tgt.clone().index_add_(axis, idx, src)

def _segment_sum(src, seg, n):
    out = torch.zeros((n,) + src.shape[1:], dtype=src.dtype)
    return out.index_add_(0, seg, src)

def _pad(x, pw):
    flat = tuple((v for pair in reversed(pw) for v in pair))
    return torch.nn.functional.pad(x, flat)
kernel_name = 'standalone__video_timesformer__vision'

def setup_inputs():

    _w = lambda a: (lambda t: t.to(torch.bfloat16) if t.is_floating_point() else t)(torch.as_tensor(a))
    T = 7
    p = 14
    HW = 384 // p * p
    N = (HW // p) ** 2
    C = 192
    return {'x': _w((lambda *s: torch.randn(*s, dtype=torch.bfloat16) * 0.05)(1, T, N, C)), 'wqkv_t': _w((lambda *s: torch.randn(*s, dtype=torch.bfloat16) * 0.05)(C, 3 * C)), 'wo_t': _w((lambda *s: torch.randn(*s, dtype=torch.bfloat16) * 0.05)(C, C)), 'wqkv_s': _w((lambda *s: torch.randn(*s, dtype=torch.bfloat16) * 0.05)(C, 3 * C)), 'wo_s': _w((lambda *s: torch.randn(*s, dtype=torch.bfloat16) * 0.4)(C, C))}

def reference(x, wqkv_t, wo_t, wqkv_s, wo_s):
    B, T, N, C = x.shape
    scale = C ** (-0.5)
    xt = (lambda x, *d: x.permute(*d))(x, 0, 2, 1, 3).reshape(B * N, T, C)
    h = _layernorm(xt, axis=-1)
    qkv = h @ wqkv_t
    q, k, v = (qkv[..., :C].clone(), qkv[..., C:2 * C].clone(), qkv[..., 2 * C:].clone())
    a = _softmax(torch.einsum('btc,bsc->bts', q, k) * scale, axis=-1)
    xt = xt + torch.einsum('bts,bsc->btc', a, v) @ wo_t
    x1 = (lambda x, *d: x.permute(*d))(xt.reshape(B, N, T, C), 0, 2, 1, 3)
    xs = x1.reshape(B * T, N, C)
    h = _layernorm(xs, axis=-1)
    qkv = h @ wqkv_s
    q, k, v = (qkv[..., :C].clone(), qkv[..., C:2 * C].clone(), qkv[..., 2 * C:].clone())
    a = _softmax(torch.einsum('bnc,bmc->bnm', q, k) * scale, axis=-1)
    xs = xs + torch.einsum('bnm,bmc->bnc', a, v) @ wo_s
    return xs.reshape(B, T, N, C)
```

```asm
; @launch grid=(256,1,1) block=(256,1,1) lds=163840
.amdgcn_target "amdgcn-amd-amdhsa--gfx950"
.text
.globl standalone__video_timesformer__vision_kernel
.p2align 8
.type standalone__video_timesformer__vision_kernel,@function
standalone__video_timesformer__vision_kernel:
    s_load_dwordx2 s[4:5], s[0:1], 0
    s_load_dwordx16 s[48:63], s[0:1], 0
    s_getpc_b64 s[70:71]
L_code_pc:
    v_add_u32 v7, 192, v0
    v_bfe_u32 v7, v7, 6, 2
    v_and_b32 v0, 63, v0
    s_cmp_ge_u32 s2, 184
    v_readfirstlane_b32 s3, v7
    s_cbranch_scc1 L_abtop
    s_mov_b32 s6, 1959552
    s_mov_b32 s7, 0x20000
    v_lshrrev_b32 v7, 5, v0
    v_lshl_add_u32 v7, s3, 1, v7
    v_bfe_u32 v8, v0, 3, 2
    v_lshl_add_u32 v8, s2, 2, v8
    v_cmp_gt_u32 vcc, 729, v8
    v_mul_u32_u24 v10, 384, v8
    v_and_b32 v11, 7, v0
    v_cndmask_b32 v7, 7, v7, vcc
    v_lshl_add_u32 v10, v11, 4, v10
    v_mul_u32_u24 v9, 279936, v7
    v_add_u32 v220, v9, v10
    s_waitcnt lgkmcnt(0)
    buffer_load_dwordx4 v[172:175], v220, s[4:7], 0 offen offset:0
    buffer_load_dwordx4 v[176:179], v220, s[4:7], 0 offen offset:128
    buffer_load_dwordx4 v[180:183], v220, s[4:7], 0 offen offset:256
    s_mov_b64 s[8:9], s[50:51]
    s_mov_b32 s10, 221184
    s_mov_b32 s11, 0x20000
    v_lshrrev_b32 v7, 3, v0
    v_bfe_u32 v8, v0, 4, 1
    v_lshlrev_b32 v8, 2, v8
    v_and_b32 v9, 7, v0
    v_xor_b32 v8, v8, v9
    v_lshlrev_b32 v8, 4, v8
    v_lshl_add_u32 v13, s3, 7, v8
    v_mul_u32_u24 v9, 1152, v7
    v_add_u32 v221, v9, v13
    v_add_u32 v222, 8192, v221
    v_add_u32 v223, 16384, v221
    v_add_u32 v224, 24576, v221
    s_mul_i32 s47, s3, 36864
    s_barrier
    s_cmp_eq_u32 s3, 3
    s_cbranch_scc1 L_noown
    s_add_u32 m0, s47, 0
    s_mov_b32 s46, 0
    buffer_load_dwordx4 v221, s[8:11], s46 offen offset:0 lds
    buffer_load_dwordx4 v222, s[8:11], s46 offen offset:1024 lds
    buffer_load_dwordx4 v223, s[8:11], s46 offen offset:2048 lds
    buffer_load_dwordx4 v224, s[8:11], s46 offen offset:3072 lds
    s_add_u32 m0, s47, 4096
    s_mov_b32 s46, 36864
    buffer_load_dwordx4 v221, s[8:11], s46 offen offset:0 lds
    buffer_load_dwordx4 v222, s[8:11], s46 offen offset:1024 lds
    buffer_load_dwordx4 v223, s[8:11], s46 offen offset:2048 lds
    buffer_load_dwordx4 v224, s[8:11], s46 offen offset:3072 lds
L_noown:
    s_branch L_main2
L_abtop:
    s_cmp_ge_u32 s2, 256
    s_cbranch_scc1 L_exit
    s_sub_u32 s32, s2, 184
    s_lshr_b32 s33, s32, 3
    s_cmp_lt_u32 s3, 2
    s_cbranch_scc1 L_ab
    v_lshl_add_u32 v7, s33, 6, v0
    s_cmp_eq_u32 s3, 3
    s_cbranch_scc1 L_wpf
    v_lshlrev_b32 v8, 7, v7
    v_min_u32 v8, L_codeend-L_code_pc-4, v8
    global_load_dword v18, v8, s[70:71]
    s_branch L_reset
L_wpf:
    v_mul_u32_u24 v8, 21846, v7
    v_lshrrev_b32 v8, 16, v8
    v_mul_u32_u24 v8, 6, v8
    v_add_lshl_u32 v8, v8, v7, 7
    v_lshlrev_b32 v7, 7, v7
    s_mov_b32 s10, 221184
    s_mov_b32 s11, 0x20000
    s_mov_b32 s14, 73728
    s_mov_b32 s15, 0x20000
    s_waitcnt lgkmcnt(0)
    s_mov_b64 s[8:9], s[50:51]
    s_mov_b64 s[12:13], s[52:53]
    buffer_load_dword v9, v8, s[8:11], 0 offen offset:0
    buffer_load_dword v10, v8, s[8:11], 0 offen offset:384
    buffer_load_dword v11, v8, s[8:11], 0 offen offset:768
    buffer_load_dword v12, v7, s[12:15], 0 offen
    s_endpgm
L_main2:
    s_mov_b64 s[12:13], s[52:53]
    s_mov_b64 s[16:17], s[62:63]
    s_mov_b64 s[20:21], s[58:59]
    s_mov_b64 s[24:25], s[60:61]
    s_mov_b32 s14, 73728
    s_mov_b32 s15, 0x20000
    s_mov_b32 s18, 4194304
    s_mov_b32 s19, 0x20000
    s_mov_b32 s22, 1959552
    s_mov_b32 s23, 0x20000
    s_mov_b32 s26, 256
    s_mov_b32 s27, 0x20000
    v_lshlrev_b32 v1, 4, v0
    v_lshrrev_b32 v7, 3, v0
    v_lshl_add_u32 v7, s3, 3, v7
    v_mul_u32_u24 v7, 400, v7
    v_and_b32 v8, 7, v0
    v_lshlrev_b32 v8, 4, v8
    v_add_u32 v7, 110592, v7
    v_add_u32 v229, v7, v8
    v_and_b32 v7, 31, v0
    v_lshlrev_b32 v9, 4, v7
    v_add_u32 v2, 151552, v9
    s_mul_i32 s28, s3, 288
    s_add_u32 s28, s28, 2392064
    v_min_u32 v9, 17, v0
    v_lshl_add_u32 v5, v9, 4, s28
    v_lshrrev_b32 v8, 5, v0
    v_mul_u32_u24 v9, 400, v7
    v_add_u32 v9, 110592, v9
    v_lshl_add_u32 v230, v8, 4, v9
    v_lshl_add_u32 v9, v8, 3, v9
    v_lshl_add_u32 v231, s3, 7, v9
    v_lshl_add_u32 v9, v8, 3, v2
    v_lshl_add_u32 v239, s3, 9, v9
    v_bfe_u32 v9, v0, 2, 2
    v_lshlrev_b32 v10, 10, v8
    v_lshl_add_u32 v10, v9, 7, v10
    v_bfe_u32 v11, v0, 3, 1
    v_lshl_add_u32 v10, v11, 6, v10
    v_bfe_u32 v11, v0, 4, 1
    v_lshl_add_u32 v10, v11, 5, v10
    v_and_b32 v11, 3, v0
    v_lshl_add_u32 v10, v11, 3, v10
    v_xor_b32 v12, 64, v10
    v_add_u32 v232, s47, v10
    v_add_u32 v233, s47, v12
    v_add_u32 v235, 148480, v1
    v_lshl_add_u32 v234, s3, 10, v235
    v_add_u32 v9, 136192, v1
    v_lshl_add_u32 v236, s3, 12, v9
    s_add_u32 s28, s3, 1
    s_sub_u32 s30, s28, 3
    s_min_u32 s28, s28, s30
    v_lshl_add_u32 v237, s28, 12, v9
    s_add_u32 s28, s3, 2
    s_sub_u32 s30, s28, 3
    s_min_u32 s28, s28, s30
    v_lshl_add_u32 v238, s28, 12, v9
    v_and_b32 v9, 1, v0
    v_lshlrev_b32 v9, 4, v9
    v_mov_b32 v10, 0xffff
    v_lshlrev_b32 v10, v9, v10
    s_mov_b32 s38, 0x22222222
    s_mov_b32 s39, s38
    s_lshl_b64 s[40:41], s[38:39], 1
    s_lshl_b64 s[42:43], s[38:39], 2
    s_mov_b32 s30, 0x33333333
    s_mov_b32 s31, s30
    s_mov_b32 s44, 0
    s_mov_b32 s45, -1
    s_mov_b32 s48, 0x3dd53b95
    v_cndmask_b32 v242, 0, v10, s[30:31]
    v_cndmask_b32 v243, v10, 0, s[30:31]
    s_lshr_b32 s28, s2, 3
    s_mul_i32 s28, s28, 12288
    s_lshl_b32 s30, s3, 12
    s_add_u32 s28, s28, s30
    s_and_b32 s30, s2, 7
    s_lshl_b32 s31, s30, 7
    s_add_u32 s28, s28, s31
    s_bfe_u32 s30, s30, 0x10001
    v_xor_b32 v9, s30, v8
    v_lshlrev_b32 v9, 6, v9
    v_lshl_add_u32 v9, v11, 4, v9
    v_lshrrev_b32 v10, 2, v7
    v_mul_u32_u24 v12, 282624, v10
    v_add3_u32 v9, v9, v12, s28
    v_cmp_gt_u32 vcc, 7, v10
    v_mov_b32 v12, 5242880
    s_nop 0
    v_cndmask_b32 v240, v12, v9, vcc
    v_xor_b32 v241, 128, v240
    v_and_b32 v13, 127, v13
    v_lshrrev_b32 v8, 5, v0
    v_bfe_u32 v9, v0, 3, 2
    v_lshl_add_u32 v9, v8, 3, v9
    v_mul_u32_u24 v9, 384, v9
    v_add_u32 v225, v9, v13
    v_add_u32 v226, 512, v225
    v_add_u32 v227, 4096, v225
    v_add_u32 v228, 4608, v225
    s_cmp_eq_u32 s3, 3
    s_cbranch_scc1 L_pre
L_back:
    s_waitcnt vmcnt(8)
    v_lshlrev_b32 v60, 16, v172
    v_and_b32 v61, 0xffff0000, v172
    v_lshlrev_b32 v62, 16, v173
    v_and_b32 v63, 0xffff0000, v173
    v_pk_add_f32 v[212:213], v[60:61], v[62:63]
    v_pk_mul_f32 v[214:215], v[60:61], v[60:61]
    v_pk_fma_f32 v[214:215], v[62:63], v[62:63], v[214:215]
    v_lshlrev_b32 v64, 16, v174
    v_and_b32 v65, 0xffff0000, v174
    v_pk_add_f32 v[212:213], v[212:213], v[64:65]
    v_pk_fma_f32 v[214:215], v[64:65], v[64:65], v[214:215]
    v_lshlrev_b32 v66, 16, v175
    v_and_b32 v67, 0xffff0000, v175
    v_pk_add_f32 v[212:213], v[212:213], v[66:67]
    v_pk_fma_f32 v[214:215], v[66:67], v[66:67], v[214:215]
    ds_write_b128 v229, v[172:175] offset:12800
    v_lshlrev_b32 v68, 16, v176
    v_and_b32 v69, 0xffff0000, v176
    v_pk_add_f32 v[212:213], v[212:213], v[68:69]
    v_pk_fma_f32 v[214:215], v[68:69], v[68:69], v[214:215]
    v_lshlrev_b32 v70, 16, v177
    v_and_b32 v71, 0xffff0000, v177
    v_pk_add_f32 v[212:213], v[212:213], v[70:71]
    v_pk_fma_f32 v[214:215], v[70:71], v[70:71], v[214:215]
    v_lshlrev_b32 v72, 16, v178
    v_and_b32 v73, 0xffff0000, v178
    v_pk_add_f32 v[212:213], v[212:213], v[72:73]
    v_pk_fma_f32 v[214:215], v[72:73], v[72:73], v[214:215]
    v_lshlrev_b32 v74, 16, v179
    v_and_b32 v75, 0xffff0000, v179
    v_pk_add_f32 v[212:213], v[212:213], v[74:75]
    v_pk_fma_f32 v[214:215], v[74:75], v[74:75], v[214:215]
    ds_write_b128 v229, v[176:179] offset:12928
    v_lshlrev_b32 v76, 16, v180
    v_and_b32 v77, 0xffff0000, v180
    v_pk_add_f32 v[212:213], v[212:213], v[76:77]
    v_pk_fma_f32 v[214:215], v[76:77], v[76:77], v[214:215]
    v_lshlrev_b32 v78, 16, v181
    v_and_b32 v79, 0xffff0000, v181
    v_pk_add_f32 v[212:213], v[212:213], v[78:79]
    v_pk_fma_f32 v[214:215], v[78:79], v[78:79], v[214:215]
    v_lshlrev_b32 v80, 16, v182
    v_and_b32 v81, 0xffff0000, v182
    v_pk_add_f32 v[212:213], v[212:213], v[80:81]
    v_pk_fma_f32 v[214:215], v[80:81], v[80:81], v[214:215]
    v_lshlrev_b32 v82, 16, v183
    v_and_b32 v83, 0xffff0000, v183
    v_pk_add_f32 v[212:213], v[212:213], v[82:83]
    v_pk_fma_f32 v[214:215], v[82:83], v[82:83], v[214:215]
    ds_write_b128 v229, v[180:183] offset:13056
    v_add_f32 v212, v212, v213
    v_add_f32 v214, v214, v215
    s_nop 0
    v_add_f32_dpp v212, v212, v212 quad_perm:[1,0,3,2] row_mask:0xf bank_mask:0xf
    v_add_f32_dpp v214, v214, v214 quad_perm:[1,0,3,2] row_mask:0xf bank_mask:0xf
    s_nop 0
    v_add_f32_dpp v212, v212, v212 quad_perm:[2,3,0,1] row_mask:0xf bank_mask:0xf
    v_add_f32_dpp v214, v214, v214 quad_perm:[2,3,0,1] row_mask:0xf bank_mask:0xf
    s_nop 0
    v_add_f32_dpp v212, v212, v212 row_half_mirror row_mask:0xf bank_mask:0xf
    v_add_f32_dpp v214, v214, v214 row_half_mirror row_mask:0xf bank_mask:0xf
    v_mul_f32 v212, 0x3baaaaab, v212
    v_mul_f32 v214, 0x3baaaaab, v214
    v_fma_f32 v214, -v212, v212, v214
    v_max_f32 v214, 0, v214
    v_add_f32 v214, 0x3727c5ac, v214
    v_rsq_f32 v216, v214
    s_nop 0
    v_mul_f32 v217, -v212, v216
    v_pk_fma_f32 v[60:61], v[60:61], v[216:217], v[216:217] op_sel:[0,0,1] op_sel_hi:[1,0,1]
    v_pk_fma_f32 v[62:63], v[62:63], v[216:217], v[216:217] op_sel:[0,0,1] op_sel_hi:[1,0,1]
    v_cvt_pk_bf16_f32 v92, v60, v61
    v_pk_fma_f32 v[64:65], v[64:65], v[216:217], v[216:217] op_sel:[0,0,1] op_sel_hi:[1,0,1]
    v_cvt_pk_bf16_f32 v93, v62, v63
    v_pk_fma_f32 v[66:67], v[66:67], v[216:217], v[216:217] op_sel:[0,0,1] op_sel_hi:[1,0,1]
    v_cvt_pk_bf16_f32 v94, v64, v65
    v_pk_fma_f32 v[68:69], v[68:69], v[216:217], v[216:217] op_sel:[0,0,1] op_sel_hi:[1,0,1]
    v_cvt_pk_bf16_f32 v95, v66, v67
    ds_write_b128 v229, v[92:95] offset:0
    v_pk_fma_f32 v[70:71], v[70:71], v[216:217], v[216:217] op_sel:[0,0,1] op_sel_hi:[1,0,1]
    v_cvt_pk_bf16_f32 v96, v68, v69
    v_pk_fma_f32 v[72:73], v[72:73], v[216:217], v[216:217] op_sel:[0,0,1] op_sel_hi:[1,0,1]
    v_cvt_pk_bf16_f32 v97, v70, v71
    v_pk_fma_f32 v[74:75], v[74:75], v[216:217], v[216:217] op_sel:[0,0,1] op_sel_hi:[1,0,1]
    v_cvt_pk_bf16_f32 v98, v72, v73
    v_pk_fma_f32 v[76:77], v[76:77], v[216:217], v[216:217] op_sel:[0,0,1] op_sel_hi:[1,0,1]
    v_cvt_pk_bf16_f32 v99, v74, v75
    ds_write_b128 v229, v[96:99] offset:128
    v_pk_fma_f32 v[78:79], v[78:79], v[216:217], v[216:217] op_sel:[0,0,1] op_sel_hi:[1,0,1]
    v_cvt_pk_bf16_f32 v100, v76, v77
    v_pk_fma_f32 v[80:81], v[80:81], v[216:217], v[216:217] op_sel:[0,0,1] op_sel_hi:[1,0,1]
    v_cvt_pk_bf16_f32 v101, v78, v79
    v_pk_fma_f32 v[82:83], v[82:83], v[216:217], v[216:217] op_sel:[0,0,1] op_sel_hi:[1,0,1]
    v_cvt_pk_bf16_f32 v102, v80, v81
    v_cvt_pk_bf16_f32 v103, v82, v83
    ds_write_b128 v229, v[100:103] offset:256
    s_cmp_eq_u32 s3, 3
    s_cbranch_scc1 L_helper
    s_waitcnt lgkmcnt(0)
    s_barrier
    ds_read_b128 a[0:3], v230 offset:0
    ds_read_b128 a[4:7], v230 offset:32
    ds_read_b128 a[8:11], v230 offset:64
    ds_read_b128 a[12:15], v230 offset:96
    ds_read_b128 a[16:19], v230 offset:128
    ds_read_b128 a[20:23], v230 offset:160
    ds_read_b128 a[24:27], v230 offset:192
    ds_read_b128 a[28:31], v230 offset:224
    ds_read_b128 a[32:35], v230 offset:256
    ds_read_b128 a[36:39], v230 offset:288
    ds_read_b128 a[40:43], v230 offset:320
    ds_read_b128 a[44:47], v230 offset:352
    s_waitcnt vmcnt(6)
    ds_read_b64_tr_b16 a[168:169], v232 offset:0
    ds_read_b64_tr_b16 a[170:171], v232 offset:512
    ds_read_b64_tr_b16 a[172:173], v233 offset:0
    ds_read_b64_tr_b16 a[174:175], v233 offset:512
    s_waitcnt vmcnt(4)
    ds_read_b64_tr_b16 a[176:177], v232 offset:2048
    ds_read_b64_tr_b16 a[178:179], v232 offset:2560
    ds_read_b64_tr_b16 a[180:181], v233 offset:2048
    ds_read_b64_tr_b16 a[182:183], v233 offset:2560
    s_waitcnt vmcnt(2) lgkmcnt(4)
    v_mfma_f32_32x32x16_bf16 v[60:75], a[168:171], a[0:3], 0
    ds_read_b64_tr_b16 a[184:185], v232 offset:4096
    ds_read_b64_tr_b16 a[186:187], v232 offset:4608
    v_mfma_f32_32x32x16_bf16 v[76:91], a[172:175], a[0:3], 0
    ds_read_b64_tr_b16 a[188:189], v233 offset:4096
    ds_read_b64_tr_b16 a[190:191], v233 offset:4608
    s_waitcnt vmcnt(0) lgkmcnt(4)
    v_mfma_f32_32x32x16_bf16 v[60:75], a[176:179], a[4:7], v[60:75]
    ds_read_b64_tr_b16 a[192:193], v232 offset:6144
    ds_read_b64_tr_b16 a[194:195], v232 offset:6656
    ds_read_b64 v[188:189], v231 offset:12800
    v_mfma_f32_32x32x16_bf16 v[76:91], a[180:183], a[4:7], v[76:91]
    ds_read_b64_tr_b16 a[196:197], v233 offset:6144
    ds_read_b64_tr_b16 a[198:199], v233 offset:6656
    ds_read_b64 v[190:191], v231 offset:12816
    s_waitcnt lgkmcnt(6)
    v_mfma_f32_32x32x16_bf16 v[60:75], a[184:187], a[8:11], v[60:75]
    s_barrier
    ds_read_b64_tr_b16 a[200:201], v232 offset:8192
    ds_read_b64_tr_b16 a[202:203], v232 offset:8704
    ds_read_b64 v[192:193], v231 offset:12832
    v_mfma_f32_32x32x16_bf16 v[76:91], a[188:191], a[8:11], v[76:91]
    ds_read_b64_tr_b16 a[204:205], v233 offset:8192
    ds_read_b64_tr_b16 a[206:207], v233 offset:8704
    ds_read_b64 v[194:195], v231 offset:12848
    s_waitcnt lgkmcnt(7)
    v_mfma_f32_32x32x16_bf16 v[60:75], a[192:195], a[12:15], v[60:75]
    ds_read_b64_tr_b16 a[208:209], v232 offset:10240
    ds_read_b64_tr_b16 a[210:211], v232 offset:10752
    ds_read_b64 v[196:197], v231 offset:12864
    v_mfma_f32_32x32x16_bf16 v[76:91], a[196:199], a[12:15], v[76:91]
    ds_read_b64_tr_b16 a[212:213], v233 offset:10240
    ds_read_b64_tr_b16 a[214:215], v233 offset:10752
    ds_read_b64 v[198:199], v231 offset:12880
    s_waitcnt lgkmcnt(7)
    v_mfma_f32_32x32x16_bf16 v[60:75], a[200:203], a[16:19], v[60:75]
    s_barrier
    ds_read_b64_tr_b16 a[168:169], v232 offset:12288
    ds_read_b64_tr_b16 a[170:171], v232 offset:12800
    ds_read_b64 v[200:201], v231 offset:12896
    v_lshlrev_b32 v124, 16, v188
    v_and_b32 v125, 0xffff0000, v188
    v_mfma_f32_32x32x16_bf16 v[76:91], a[204:207], a[16:19], v[76:91]
    ds_read_b64_tr_b16 a[172:173], v233 offset:12288
    ds_read_b64_tr_b16 a[174:175], v233 offset:12800
    ds_read_b64 v[202:203], v231 offset:12912
    v_lshlrev_b32 v126, 16, v189
    v_and_b32 v127, 0xffff0000, v189
    s_waitcnt lgkmcnt(7)
    v_mfma_f32_32x32x16_bf16 v[60:75], a[208:211], a[20:23], v[60:75]
    ds_read_b64_tr_b16 a[176:177], v232 offset:14336
    ds_read_b64_tr_b16 a[178:179], v232 offset:14848
    v_lshlrev_b32 v128, 16, v190
    v_and_b32 v129, 0xffff0000, v190
    v_mfma_f32_32x32x16_bf16 v[76:91], a[212:215], a[20:23], v[76:91]
    ds_read_b64_tr_b16 a[180:181], v233 offset:14336
    ds_read_b64_tr_b16 a[182:183], v233 offset:14848
    v_lshlrev_b32 v130, 16, v191
    v_and_b32 v131, 0xffff0000, v191
    s_waitcnt lgkmcnt(5)
    v_mfma_f32_32x32x16_bf16 v[60:75], a[168:171], a[24:27], v[60:75]
    s_barrier
    ds_read_b64_tr_b16 a[184:185], v232 offset:16384
    ds_read_b64_tr_b16 a[186:187], v232 offset:16896
    v_lshlrev_b32 v132, 16, v192
    v_and_b32 v133, 0xffff0000, v192
    v_mfma_f32_32x32x16_bf16 v[76:91], a[172:175], a[24:27], v[76:91]
    ds_read_b64_tr_b16 a[188:189], v233 offset:16384
    ds_read_b64_tr_b16 a[190:191], v233 offset:16896
    v_lshlrev_b32 v134, 16, v193
    v_and_b32 v135, 0xffff0000, v193
    s_waitcnt lgkmcnt(4)
    v_mfma_f32_32x32x16_bf16 v[60:75], a[176:179], a[28:31], v[60:75]
    ds_read_b64_tr_b16 a[192:193], v232 offset:18432
    ds_read_b64_tr_b16 a[194:195], v232 offset:18944
    v_lshlrev_b32 v136, 16, v194
    v_and_b32 v137, 0xffff0000, v194
    v_mfma_f32_32x32x16_bf16 v[76:91], a[180:183], a[28:31], v[76:91]
    ds_read_b64_tr_b16 a[196:197], v233 offset:18432
    ds_read_b64_tr_b16 a[198:199], v233 offset:18944
    v_lshlrev_b32 v138, 16, v195
    v_and_b32 v139, 0xffff0000, v195
    s_waitcnt lgkmcnt(4)
    v_mfma_f32_32x32x16_bf16 v[60:75], a[184:187], a[32:35], v[60:75]
    s_barrier
    ds_read_b64_tr_b16 a[200:201], v232 offset:20480
    ds_read_b64_tr_b16 a[202:203], v232 offset:20992
    v_lshlrev_b32 v140, 16, v196
    v_and_b32 v141, 0xffff0000, v196
    v_mfma_f32_32x32x16_bf16 v[76:91], a[188:191], a[32:35], v[76:91]
    ds_read_b64_tr_b16 a[204:205], v233 offset:20480
    ds_read_b64_tr_b16 a[206:207], v233 offset:20992
    v_lshlrev_b32 v142, 16, v197
    v_and_b32 v143, 0xffff0000, v197
    s_waitcnt lgkmcnt(4)
    v_mfma_f32_32x32x16_bf16 v[60:75], a[192:195], a[36:39], v[60:75]
    ds_read_b64_tr_b16 a[208:209], v232 offset:22528
    ds_read_b64_tr_b16 a[210:211], v232 offset:23040
    v_lshlrev_b32 v144, 16, v198
    v_and_b32 v145, 0xffff0000, v198
    v_mfma_f32_32x32x16_bf16 v[76:91], a[196:199], a[36:39], v[76:91]
    ds_read_b64_tr_b16 a[212:213], v233 offset:22528
    ds_read_b64_tr_b16 a[214:215], v233 offset:23040
    v_lshlrev_b32 v146, 16, v199
    v_and_b32 v147, 0xffff0000, v199
    s_waitcnt lgkmcnt(4)
    v_mfma_f32_32x32x16_bf16 v[60:75], a[200:203], a[40:43], v[60:75]
    s_barrier
    ds_read_b64_tr_b16 a[168:169], v232 offset:24576
    ds_read_b64_tr_b16 a[170:171], v232 offset:25088
    v_lshlrev_b32 v148, 16, v200
    v_and_b32 v149, 0xffff0000, v200
    v_mfma_f32_32x32x16_bf16 v[76:91], a[204:207], a[40:43], v[76:91]
    ds_read_b64_tr_b16 a[172:173], v233 offset:24576
    ds_read_b64_tr_b16 a[174:175], v233 offset:25088
    v_lshlrev_b32 v150, 16, v201
    v_and_b32 v151, 0xffff0000, v201
    s_waitcnt lgkmcnt(4)
    v_mfma_f32_32x32x16_bf16 v[60:75], a[208:211], a[44:47], v[60:75]
    ds_read_b64_tr_b16 a[176:177], v232 offset:26624
    ds_read_b64_tr_b16 a[178:179], v232 offset:27136
    v_lshlrev_b32 v152, 16, v202
    v_and_b32 v153, 0xffff0000, v202
    v_mfma_f32_32x32x16_bf16 v[76:91], a[212:215], a[44:47], v[76:91]
    ds_read_b64_tr_b16 a[180:181], v233 offset:26624
    ds_read_b64_tr_b16 a[182:183], v233 offset:27136
    v_lshlrev_b32 v154, 16, v203
    v_and_b32 v155, 0xffff0000, v203
    s_waitcnt lgkmcnt(4)
    v_mfma_f32_32x32x16_bf16 v[92:107], a[168:171], a[0:3], 0
    s_barrier
    ds_read_b64_tr_b16 a[184:185], v232 offset:28672
    ds_read_b64_tr_b16 a[186:187], v232 offset:29184
    v_mfma_f32_32x32x16_bf16 v[108:123], a[172:175], a[0:3], 0
    ds_read_b64_tr_b16 a[188:189], v233 offset:28672
    ds_read_b64_tr_b16 a[190:191], v233 offset:29184
    s_waitcnt lgkmcnt(4)
    v_mfma_f32_32x32x16_bf16 v[92:107], a[176:179], a[4:7], v[92:107]
    ds_read_b64_tr_b16 a[192:193], v232 offset:30720
    ds_read_b64_tr_b16 a[194:195], v232 offset:31232
    v_mfma_f32_32x32x16_bf16 v[108:123], a[180:183], a[4:7], v[108:123]
    ds_read_b64_tr_b16 a[196:197], v233 offset:30720
    ds_read_b64_tr_b16 a[198:199], v233 offset:31232
    v_cvt_pk_bf16_f32 v156, v60, v61
    s_waitcnt lgkmcnt(4)
    v_mfma_f32_32x32x16_bf16 v[92:107], a[184:187], a[8:11], v[92:107]
    s_barrier
    ds_read_b64_tr_b16 a[200:201], v232 offset:32768
    ds_read_b64_tr_b16 a[202:203], v232 offset:33280
    v_cvt_pk_bf16_f32 v157, v62, v63
    v_mfma_f32_32x32x16_bf16 v[108:123], a[188:191], a[8:11], v[108:123]
    ds_read_b64_tr_b16 a[204:205], v233 offset:32768
    ds_read_b64_tr_b16 a[206:207], v233 offset:33280
    v_cvt_pk_bf16_f32 v158, v64, v65
    s_waitcnt lgkmcnt(4)
    v_mfma_f32_32x32x16_bf16 v[92:107], a[192:195], a[12:15], v[92:107]
    ds_read_b64_tr_b16 a[208:209], v232 offset:34816
    ds_read_b64_tr_b16 a[210:211], v232 offset:35328
    v_cvt_pk_bf16_f32 v159, v66, v67
    v_mfma_f32_32x32x16_bf16 v[108:123], a[196:199], a[12:15], v[108:123]
    ds_read_b64_tr_b16 a[212:213], v233 offset:34816
    ds_read_b64_tr_b16 a[214:215], v233 offset:35328
    v_cvt_pk_bf16_f32 v160, v68, v69
    s_waitcnt lgkmcnt(4)
    v_mfma_f32_32x32x16_bf16 v[92:107], a[200:203], a[16:19], v[92:107]
    s_barrier
    ds_read_b64_tr_b16 a[168:169], v232 offset:0
    ds_read_b64_tr_b16 a[170:171], v232 offset:512
    v_cvt_pk_bf16_f32 v161, v70, v71
    v_mfma_f32_32x32x16_bf16 v[108:123], a[204:207], a[16:19], v[108:123]
    ds_read_b64_tr_b16 a[172:173], v233 offset:0
    ds_read_b64_tr_b16 a[174:175], v233 offset:512
    v_cvt_pk_bf16_f32 v162, v72, v73
    s_waitcnt lgkmcnt(4)
    v_mfma_f32_32x32x16_bf16 v[92:107], a[208:211], a[20:23], v[92:107]
    ds_read_b64_tr_b16 a[176:177], v232 offset:2048
    ds_read_b64_tr_b16 a[178:179], v232 offset:2560
    v_cvt_pk_bf16_f32 v163, v74, v75
    v_mfma_f32_32x32x16_bf16 v[108:123], a[212:215], a[20:23], v[108:123]
    ds_read_b64_tr_b16 a[180:181], v233 offset:2048
    ds_read_b64_tr_b16 a[182:183], v233 offset:2560
    v_cvt_pk_bf16_f32 v164, v76, v77
    s_waitcnt lgkmcnt(4)
    v_mfma_f32_32x32x16_bf16 v[92:107], a[168:171], a[24:27], v[92:107]
    s_barrier
    ds_read_b64_tr_b16 a[184:185], v232 offset:4096
    ds_read_b64_tr_b16 a[186:187], v232 offset:4608
    v_cvt_pk_bf16_f32 v165, v78, v79
    v_mfma_f32_32x32x16_bf16 v[108:123], a[172:175], a[24:27], v[108:123]
    ds_read_b64_tr_b16 a[188:189], v233 offset:4096
    ds_read_b64_tr_b16 a[190:191], v233 offset:4608
    v_cvt_pk_bf16_f32 v166, v80, v81
    s_waitcnt lgkmcnt(4)
    v_mfma_f32_32x32x16_bf16 v[92:107], a[176:179], a[28:31], v[92:107]
    ds_read_b64_tr_b16 a[192:193], v232 offset:6144
    ds_read_b64_tr_b16 a[194:195], v232 offset:6656
    v_cvt_pk_bf16_f32 v167, v82, v83
    v_mfma_f32_32x32x16_bf16 v[108:123], a[180:183], a[28:31], v[108:123]
    s_barrier
    ds_read_b64_tr_b16 a[196:197], v232 offset:8192
    ds_read_b64_tr_b16 a[198:199], v232 offset:8704
    v_cvt_pk_bf16_f32 v168, v84, v85
    s_waitcnt lgkmcnt(4)
    v_mfma_f32_32x32x16_bf16 v[92:107], a[184:187], a[32:35], v[92:107]
    ds_read_b64_tr_b16 a[200:201], v232 offset:10240
    ds_read_b64_tr_b16 a[202:203], v232 offset:10752
    v_cvt_pk_bf16_f32 v169, v86, v87
    v_mfma_f32_32x32x16_bf16 v[108:123], a[188:191], a[32:35], v[108:123]
    ds_read_b64_tr_b16 a[204:205], v233 offset:6144
    ds_read_b64_tr_b16 a[206:207], v233 offset:6656
    v_cvt_pk_bf16_f32 v170, v88, v89
    s_waitcnt lgkmcnt(4)
    v_mfma_f32_32x32x16_bf16 v[92:107], a[192:195], a[36:39], v[92:107]
    ds_read_b64_tr_b16 a[208:209], v233 offset:8192
    ds_read_b64_tr_b16 a[210:211], v233 offset:8704
    v_cvt_pk_bf16_f32 v171, v90, v91
    v_mfma_f32_32x32x16_bf16 v[92:107], a[196:199], a[40:43], v[92:107]
    ds_read_b64_tr_b16 a[212:213], v233 offset:10240
    ds_read_b64_tr_b16 a[214:215], v233 offset:10752
    s_waitcnt lgkmcnt(4)
    v_mfma_f32_32x32x16_bf16 v[92:107], a[200:203], a[44:47], v[92:107]
    s_barrier
    ds_read_b64_tr_b16 a[168:169], v232 offset:12288
    ds_read_b64_tr_b16 a[170:171], v232 offset:12800
    v_mfma_f32_32x32x16_bf16 v[108:123], a[204:207], a[36:39], v[108:123]
    s_waitcnt lgkmcnt(2)
    v_mfma_f32_32x32x16_bf16 v[108:123], a[208:211], a[40:43], v[108:123]
    v_mfma_f32_32x32x16_bf16 v[108:123], a[212:215], a[44:47], v[108:123]
    ds_read_b64_tr_b16 a[172:173], v233 offset:12288
    ds_read_b64_tr_b16 a[174:175], v233 offset:12800
    s_nop 2
    v_cvt_pk_bf16_f32 v172, v92, v93
    v_cvt_pk_bf16_f32 v173, v94, v95
    v_cvt_pk_bf16_f32 v174, v96, v97
    v_cvt_pk_bf16_f32 v175, v98, v99
    s_waitcnt lgkmcnt(2)
    v_mfma_f32_32x32x16_bf16 v[60:75], a[0:3], a[168:171], 0
    v_cvt_pk_bf16_f32 v176, v100, v101
    v_cvt_pk_bf16_f32 v177, v102, v103
    v_cvt_pk_bf16_f32 v178, v104, v105
    v_cvt_pk_bf16_f32 v179, v106, v107
    v_mfma_f32_32x32x16_bf16 v[188:203], v[172:175], v[156:159], 0
    s_waitcnt lgkmcnt(0)
    v_mfma_f32_32x32x16_bf16 v[188:203], v[176:179], v[160:163], v[188:203]
    ds_read_b64_tr_b16 a[176:177], v232 offset:14336
    ds_read_b64_tr_b16 a[178:179], v232 offset:14848
    v_cvt_pk_bf16_f32 v180, v108, v109
    v_cvt_pk_bf16_f32 v181, v110, v111
    v_cvt_pk_bf16_f32 v182, v112, v113
    v_cvt_pk_bf16_f32 v183, v114, v115
    v_mfma_f32_32x32x16_bf16 v[76:91], a[0:3], a[172:175], 0
    ds_read_b64_tr_b16 a[180:181], v233 offset:14336
    ds_read_b64_tr_b16 a[182:183], v233 offset:14848
    v_cvt_pk_bf16_f32 v184, v116, v117
    v_cvt_pk_bf16_f32 v185, v118, v119
    v_cvt_pk_bf16_f32 v186, v120, v121
    v_cvt_pk_bf16_f32 v187, v122, v123
    v_mfma_f32_32x32x16_bf16 v[188:203], v[180:183], v[164:167], v[188:203]
    s_barrier
    ds_read_b64_tr_b16 a[184:185], v232 offset:16384
    ds_read_b64_tr_b16 a[186:187], v232 offset:16896
    v_mfma_f32_32x32x16_bf16 v[188:203], v[184:187], v[168:171], v[188:203]
    ds_read_b64_tr_b16 a[188:189], v233 offset:16384
    ds_read_b64_tr_b16 a[190:191], v233 offset:16896
    v_mov_b32 v10, 0xff800000
    s_waitcnt lgkmcnt(4)
    v_mfma_f32_32x32x16_bf16 v[60:75], a[4:7], a[176:179], v[60:75]
    ds_read_b64_tr_b16 a[192:193], v232 offset:18432
    ds_read_b64_tr_b16 a[194:195], v232 offset:18944
    v_mfma_f32_32x32x16_bf16 v[76:91], a[4:7], a[180:183], v[76:91]
    ds_read_b64_tr_b16 a[196:197], v233 offset:18432
    ds_read_b64_tr_b16 a[198:199], v233 offset:18944
    s_nop 1
    v_cndmask_b32 v212, v188, v189, s[38:39]
    v_cndmask_b32 v213, v192, v193, s[38:39]
    v_cndmask_b32 v214, v196, v197, s[38:39]
    v_cndmask_b32 v215, v200, v201, s[38:39]
    s_waitcnt lgkmcnt(4)
    v_mfma_f32_32x32x16_bf16 v[60:75], a[8:11], a[184:187], v[60:75]
    s_barrier
    ds_read_b64_tr_b16 a[200:201], v232 offset:20480
    ds_read_b64_tr_b16 a[202:203], v232 offset:20992
    v_cndmask_b32 v212, v212, v190, s[40:41]
    v_cndmask_b32 v213, v213, v194, s[40:41]
    v_cndmask_b32 v214, v214, v198, s[40:41]
    v_cndmask_b32 v215, v215, v202, s[40:41]
    v_mfma_f32_32x32x16_bf16 v[76:91], a[8:11], a[188:191], v[76:91]
    ds_read_b64_tr_b16 a[204:205], v233 offset:20480
    ds_read_b64_tr_b16 a[206:207], v233 offset:20992
    v_cndmask_b32 v212, v212, v191, s[42:43]
    v_cndmask_b32 v213, v213, v195, s[42:43]
    v_cndmask_b32 v214, v214, v199, s[42:43]
    v_cndmask_b32 v215, v215, v203, s[42:43]
    s_waitcnt lgkmcnt(4)
    v_mfma_f32_32x32x16_bf16 v[60:75], a[12:15], a[192:195], v[60:75]
    ds_read_b64_tr_b16 a[208:209], v232 offset:22528
    ds_read_b64_tr_b16 a[210:211], v232 offset:23040
    ds_write_b128 v234, v[212:215]
    v_mfma_f32_32x32x16_bf16 v[76:91], a[12:15], a[196:199], v[76:91]
    ds_read_b64_tr_b16 a[212:213], v233 offset:22528
    ds_read_b64_tr_b16 a[214:215], v233 offset:23040
    s_waitcnt lgkmcnt(5)
    v_mfma_f32_32x32x16_bf16 v[60:75], a[16:19], a[200:203], v[60:75]
    s_waitcnt lgkmcnt(2)
    s_barrier
    ds_read_b128 v[188:191], v235 offset:0
    ds_read_b128 v[192:195], v235 offset:1024
    ds_read_b128 v[196:199], v235 offset:2048
    ds_read_b64_tr_b16 a[168:169], v232 offset:24576
    ds_read_b64_tr_b16 a[170:171], v232 offset:25088
    v_mfma_f32_32x32x16_bf16 v[76:91], a[16:19], a[204:207], v[76:91]
    ds_read_b64_tr_b16 a[172:173], v233 offset:24576
    ds_read_b64_tr_b16 a[174:175], v233 offset:25088
    s_waitcnt lgkmcnt(7)
    v_mfma_f32_32x32x16_bf16 v[60:75], a[20:23], a[208:211], v[60:75]
    ds_read_b64_tr_b16 a[176:177], v232 offset:26624
    ds_read_b64_tr_b16 a[178:179], v232 offset:27136
    s_waitcnt lgkmcnt(7)
    v_add_f32 v188, v188, v192
    v_add_f32 v189, v189, v193
    v_add_f32 v190, v190, v194
    v_add_f32 v191, v191, v195
    v_mfma_f32_32x32x16_bf16 v[76:91], a[20:23], a[212:215], v[76:91]
    ds_read_b64_tr_b16 a[180:181], v233 offset:26624
    ds_read_b64_tr_b16 a[182:183], v233 offset:27136
    s_waitcnt lgkmcnt(8)
    v_add_f32 v188, v188, v196
    v_add_f32 v189, v189, v197
    v_add_f32 v190, v190, v198
    v_add_f32 v191, v191, v199
    s_waitcnt lgkmcnt(4)
    v_mfma_f32_32x32x16_bf16 v[60:75], a[24:27], a[168:171], v[60:75]
    s_barrier
    ds_read_b64_tr_b16 a[184:185], v232 offset:28672
    ds_read_b64_tr_b16 a[186:187], v232 offset:29184
    v_cndmask_b32 v191, v191, v10, s[44:45]
    v_max3_f32 v8, v188, v189, v190
    v_max_f32 v8, v8, v191
    v_mov_b32 v9, v8
    v_mfma_f32_32x32x16_bf16 v[76:91], a[24:27], a[172:175], v[76:91]
    ds_read_b64_tr_b16 a[188:189], v233 offset:28672
    ds_read_b64_tr_b16 a[190:191], v233 offset:29184
    v_permlane32_swap_b32 v8, v9
    v_max_f32 v8, v8, v9
    v_mul_f32 v8, s48, v8
    s_waitcnt lgkmcnt(4)
    v_mfma_f32_32x32x16_bf16 v[60:75], a[28:31], a[176:179], v[60:75]
    ds_read_b64_tr_b16 a[192:193], v232 offset:30720
    ds_read_b64_tr_b16 a[194:195], v232 offset:31232
    v_fma_f32 v188, v188, s48, -v8
    v_fma_f32 v189, v189, s48, -v8
    v_fma_f32 v190, v190, s48, -v8
    v_mfma_f32_32x32x16_bf16 v[76:91], a[28:31], a[180:183], v[76:91]
    s_barrier
    ds_read_b64_tr_b16 a[196:197], v232 offset:32768
    ds_read_b64_tr_b16 a[198:199], v232 offset:33280
    v_fma_f32 v191, v191, s48, -v8
    v_exp_f32 v188, v188
    v_exp_f32 v189, v189
    s_waitcnt lgkmcnt(4)
    v_mfma_f32_32x32x16_bf16 v[60:75], a[32:35], a[184:187], v[60:75]
    ds_read_b64_tr_b16 a[200:201], v232 offset:34816
    ds_read_b64_tr_b16 a[202:203], v232 offset:35328
    v_exp_f32 v190, v190
    v_exp_f32 v191, v191
    v_add_f32 v8, v188, v189
    v_mfma_f32_32x32x16_bf16 v[76:91], a[32:35], a[188:191], v[76:91]
    ds_read_b64_tr_b16 a[204:205], v233 offset:30720
    ds_read_b64_tr_b16 a[206:207], v233 offset:31232
    v_add_f32 v9, v190, v191
    v_add_f32 v8, v8, v9
    v_mov_b32 v9, v8
    s_waitcnt lgkmcnt(4)
    v_mfma_f32_32x32x16_bf16 v[60:75], a[36:39], a[192:195], v[60:75]
    ds_read_b64_tr_b16 a[208:209], v233 offset:32768
    ds_read_b64_tr_b16 a[210:211], v233 offset:33280
    v_permlane32_swap_b32 v8, v9
    v_add_f32 v8, v8, v9
    v_rcp_f32 v8, v8
    v_mfma_f32_32x32x16_bf16 v[60:75], a[40:43], a[196:199], v[60:75]
    ds_read_b64_tr_b16 a[212:213], v233 offset:34816
    ds_read_b64_tr_b16 a[214:215], v233 offset:35328
    v_mul_f32 v188, v188, v8
    v_mul_f32 v189, v189, v8
    v_mul_f32 v190, v190, v8
    v_mul_f32 v191, v191, v8
    s_waitcnt lgkmcnt(4)
    v_mfma_f32_32x32x16_bf16 v[60:75], a[44:47], a[200:203], v[60:75]
    v_cvt_pk_bf16_f32 v188, v188, v188
    v_cvt_pk_bf16_f32 v189, v189, v189
    v_cvt_pk_bf16_f32 v190, v190, v190
    v_cvt_pk_bf16_f32 v191, v191, v191
    v_mfma_f32_32x32x16_bf16 v[76:91], a[36:39], a[204:207], v[76:91]
    v_and_b32 v204, v188, v242
    v_and_b32 v205, v188, v243
    v_and_b32 v206, v189, v242
    v_and_b32 v207, v189, v243
    s_waitcnt lgkmcnt(0)
    v_mfma_f32_32x32x16_bf16 v[76:91], a[40:43], a[208:211], v[76:91]
    v_and_b32 v208, v190, v242
    v_and_b32 v209, v190, v243
    v_and_b32 v210, v191, v242
    v_and_b32 v211, v191, v243
    v_mfma_f32_32x32x16_bf16 v[76:91], a[44:47], a[212:215], v[76:91]
    v_cvt_pk_bf16_f32 v172, v60, v61
    v_cvt_pk_bf16_f32 v173, v62, v63
    v_cvt_pk_bf16_f32 v174, v64, v65
    v_cvt_pk_bf16_f32 v175, v66, v67
    s_nop 1
    v_mfma_f32_32x32x16_bf16 v[92:107], v[172:175], v[204:207], 0
    s_barrier
    ds_read_b64_tr_b16 a[168:169], v232 offset:0
    ds_read_b64_tr_b16 a[170:171], v232 offset:512
    v_cvt_pk_bf16_f32 v176, v68, v69
    v_cvt_pk_bf16_f32 v177, v70, v71
    v_cvt_pk_bf16_f32 v178, v72, v73
    v_cvt_pk_bf16_f32 v179, v74, v75
    s_nop 1
    v_mfma_f32_32x32x16_bf16 v[92:107], v[176:179], v[208:211], v[92:107]
    ds_read_b64_tr_b16 a[172:173], v233 offset:0
    ds_read_b64_tr_b16 a[174:175], v233 offset:512
    v_cvt_pk_bf16_f32 v180, v76, v77
    v_cvt_pk_bf16_f32 v181, v78, v79
    v_cvt_pk_bf16_f32 v182, v80, v81
    v_cvt_pk_bf16_f32 v183, v82, v83
    s_nop 1
    v_mfma_f32_32x32x16_bf16 v[108:123], v[180:183], v[204:207], 0
    ds_read_b64_tr_b16 a[176:177], v232 offset:2048
    ds_read_b64_tr_b16 a[178:179], v232 offset:2560
    v_cvt_pk_bf16_f32 v184, v84, v85
    v_cvt_pk_bf16_f32 v185, v86, v87
    v_cvt_pk_bf16_f32 v186, v88, v89
    v_cvt_pk_bf16_f32 v187, v90, v91
    s_nop 1
    v_mfma_f32_32x32x16_bf16 v[108:123], v[184:187], v[208:211], v[108:123]
    ds_read_b64_tr_b16 a[180:181], v233 offset:2048
    ds_read_b64_tr_b16 a[182:183], v233 offset:2560
    v_cvt_pk_bf16_f32 v156, v92, v93
    v_cvt_pk_bf16_f32 v157, v94, v95
    v_cvt_pk_bf16_f32 v158, v96, v97
    v_cvt_pk_bf16_f32 v159, v98, v99
    s_waitcnt lgkmcnt(4)
    s_nop 0
    v_mfma_f32_32x32x16_bf16 v[124:139], a[168:171], v[156:159], v[124:139]
    s_barrier
    ds_read_b64_tr_b16 a[184:185], v232 offset:4096
    ds_read_b64_tr_b16 a[186:187], v232 offset:4608
    ds_write_b128 v236, v[156:159] offset:0
    v_cvt_pk_bf16_f32 v160, v100, v101
    v_cvt_pk_bf16_f32 v161, v102, v103
    v_cvt_pk_bf16_f32 v162, v104, v105
    v_cvt_pk_bf16_f32 v163, v106, v107
    v_mfma_f32_32x32x16_bf16 v[140:155], a[172:175], v[156:159], v[140:155]
    ds_read_b64_tr_b16 a[188:189], v233 offset:4096
    ds_read_b64_tr_b16 a[190:191], v233 offset:4608
    ds_write_b128 v236, v[160:163] offset:1024
    v_cvt_pk_bf16_f32 v164, v108, v109
    v_cvt_pk_bf16_f32 v165, v110, v111
    v_cvt_pk_bf16_f32 v166, v112, v113
    v_cvt_pk_bf16_f32 v167, v114, v115
    s_waitcnt lgkmcnt(6)
    v_mfma_f32_32x32x16_bf16 v[124:139], a[176:179], v[160:163], v[124:139]
    ds_read_b64_tr_b16 a[192:193], v232 offset:6144
    ds_read_b64_tr_b16 a[194:195], v232 offset:6656
    ds_write_b128 v236, v[164:167] offset:2048
    v_cvt_pk_bf16_f32 v168, v116, v117
    v_cvt_pk_bf16_f32 v169, v118, v119
    v_cvt_pk_bf16_f32 v170, v120, v121
    v_cvt_pk_bf16_f32 v171, v122, v123
    v_mfma_f32_32x32x16_bf16 v[140:155], a[180:183], v[160:163], v[140:155]
    ds_read_b64_tr_b16 a[196:197], v233 offset:6144
    ds_read_b64_tr_b16 a[198:199], v233 offset:6656
    ds_write_b128 v236, v[168:171] offset:3072
    s_waitcnt lgkmcnt(7)
    v_mfma_f32_32x32x16_bf16 v[124:139], a[184:187], v[164:167], v[124:139]
    s_waitcnt lgkmcnt(0)
    s_barrier
    ds_read_b64_tr_b16 a[200:201], v232 offset:8192
    ds_read_b64_tr_b16 a[202:203], v232 offset:8704
    ds_read_b128 a[16:19], v237 offset:0
    ds_read_b128 a[20:23], v237 offset:1024
    v_mfma_f32_32x32x16_bf16 v[140:155], a[188:191], v[164:167], v[140:155]
    ds_read_b64_tr_b16 a[204:205], v233 offset:8192
    ds_read_b64_tr_b16 a[206:207], v233 offset:8704
    ds_read_b128 a[24:27], v237 offset:2048
    ds_read_b128 a[28:31], v237 offset:3072
    v_mfma_f32_32x32x16_bf16 v[124:139], a[192:195], v[168:171], v[124:139]
    ds_read_b64_tr_b16 a[208:209], v232 offset:10240
    ds_read_b64_tr_b16 a[210:211], v232 offset:10752
    ds_read_b128 a[32:35], v238 offset:0
    ds_read_b128 a[36:39], v238 offset:1024
    v_mfma_f32_32x32x16_bf16 v[140:155], a[196:199], v[168:171], v[140:155]
    ds_read_b64_tr_b16 a[212:213], v233 offset:10240
    ds_read_b64_tr_b16 a[214:215], v233 offset:10752
    ds_read_b128 a[40:43], v238 offset:2048
    ds_read_b128 a[44:47], v238 offset:3072
    s_waitcnt lgkmcnt(10)
    v_mfma_f32_32x32x16_bf16 v[124:139], a[200:203], a[16:19], v[124:139]
    s_barrier
    ds_read_b64_tr_b16 a[168:169], v232 offset:12288
    ds_read_b64_tr_b16 a[170:171], v232 offset:12800
    v_mfma_f32_32x32x16_bf16 v[140:155], a[204:207], a[16:19], v[140:155]
    ds_read_b64_tr_b16 a[172:173], v233 offset:12288
    ds_read_b64_tr_b16 a[174:175], v233 offset:12800
    s_waitcnt lgkmcnt(6)
    v_mfma_f32_32x32x16_bf16 v[124:139], a[208:211], a[20:23], v[124:139]
    ds_read_b64_tr_b16 a[176:177], v232 offset:14336
    ds_read_b64_tr_b16 a[178:179], v232 offset:14848
    v_mfma_f32_32x32x16_bf16 v[140:155], a[212:215], a[20:23], v[140:155]
    ds_read_b64_tr_b16 a[180:181], v233 offset:14336
    ds_read_b64_tr_b16 a[182:183], v233 offset:14848
    s_waitcnt lgkmcnt(4)
    v_mfma_f32_32x32x16_bf16 v[124:139], a[168:171], a[24:27], v[124:139]
    s_barrier
    ds_read_b64_tr_b16 a[184:185], v232 offset:16384
    ds_read_b64_tr_b16 a[186:187], v232 offset:16896
    v_mfma_f32_32x32x16_bf16 v[140:155], a[172:175], a[24:27], v[140:155]
    ds_read_b64_tr_b16 a[188:189], v233 offset:16384
    ds_read_b64_tr_b16 a[190:191], v233 offset:16896
    s_waitcnt lgkmcnt(4)
    v_mfma_f32_32x32x16_bf16 v[124:139], a[176:179], a[28:31], v[124:139]
    ds_read_b64_tr_b16 a[192:193], v232 offset:18432
    ds_read_b64_tr_b16 a[194:195], v232 offset:18944
    v_mfma_f32_32x32x16_bf16 v[140:155], a[180:183], a[28:31], v[140:155]
    ds_read_b64_tr_b16 a[196:197], v233 offset:18432
    ds_read_b64_tr_b16 a[198:199], v233 offset:18944
    s_waitcnt lgkmcnt(4)
    v_mfma_f32_32x32x16_bf16 v[124:139], a[184:187], a[32:35], v[124:139]
    s_barrier
    ds_read_b64_tr_b16 a[200:201], v232 offset:20480
    ds_read_b64_tr_b16 a[202:203], v232 offset:20992
    v_mfma_f32_32x32x16_bf16 v[140:155], a[188:191], a[32:35], v[140:155]
    ds_read_b64_tr_b16 a[204:205], v233 offset:20480
    ds_read_b64_tr_b16 a[206:207], v233 offset:20992
    s_waitcnt lgkmcnt(4)
    v_mfma_f32_32x32x16_bf16 v[124:139], a[192:195], a[36:39], v[124:139]
    ds_read_b64_tr_b16 a[208:209], v232 offset:22528
    ds_read_b64_tr_b16 a[210:211], v232 offset:23040
    v_mfma_f32_32x32x16_bf16 v[140:155], a[196:199], a[36:39], v[140:155]
    ds_read_b64_tr_b16 a[212:213], v233 offset:22528
    ds_read_b64_tr_b16 a[214:215], v233 offset:23040
    s_waitcnt lgkmcnt(4)
    v_mfma_f32_32x32x16_bf16 v[124:139], a[200:203], a[40:43], v[124:139]
    v_mfma_f32_32x32x16_bf16 v[140:155], a[204:207], a[40:43], v[140:155]
    s_waitcnt lgkmcnt(0)
    v_mfma_f32_32x32x16_bf16 v[124:139], a[208:211], a[44:47], v[124:139]
    v_mfma_f32_32x32x16_bf16 v[140:155], a[212:215], a[44:47], v[140:155]
    s_nop 10
    v_pk_add_f32 v[212:213], v[124:125], v[126:127]
    v_pk_mul_f32 v[214:215], v[124:125], v[124:125]
    v_pk_fma_f32 v[214:215], v[126:127], v[126:127], v[214:215]
    v_pk_add_f32 v[212:213], v[212:213], v[128:129]
    v_pk_fma_f32 v[214:215], v[128:129], v[128:129], v[214:215]
    v_pk_add_f32 v[212:213], v[212:213], v[130:131]
    v_pk_fma_f32 v[214:215], v[130:131], v[130:131], v[214:215]
    v_pk_add_f32 v[212:213], v[212:213], v[132:133]
    v_pk_fma_f32 v[214:215], v[132:133], v[132:133], v[214:215]
    v_pk_add_f32 v[212:213], v[212:213], v[134:135]
    v_pk_fma_f32 v[214:215], v[134:135], v[134:135], v[214:215]
    v_pk_add_f32 v[212:213], v[212:213], v[136:137]
    v_pk_fma_f32 v[214:215], v[136:137], v[136:137], v[214:215]
    v_pk_add_f32 v[212:213], v[212:213], v[138:139]
    v_pk_fma_f32 v[214:215], v[138:139], v[138:139], v[214:215]
    v_pk_add_f32 v[212:213], v[212:213], v[140:141]
    v_pk_fma_f32 v[214:215], v[140:141], v[140:141], v[214:215]
    v_pk_add_f32 v[212:213], v[212:213], v[142:143]
    v_pk_fma_f32 v[214:215], v[142:143], v[142:143], v[214:215]
    v_pk_add_f32 v[212:213], v[212:213], v[144:145]
    v_pk_fma_f32 v[214:215], v[144:145], v[144:145], v[214:215]
    v_pk_add_f32 v[212:213], v[212:213], v[146:147]
    v_pk_fma_f32 v[214:215], v[146:147], v[146:147], v[214:215]
    v_pk_add_f32 v[212:213], v[212:213], v[148:149]
    v_pk_fma_f32 v[214:215], v[148:149], v[148:149], v[214:215]
    v_pk_add_f32 v[212:213], v[212:213], v[150:151]
    v_pk_fma_f32 v[214:215], v[150:151], v[150:151], v[214:215]
    v_pk_add_f32 v[212:213], v[212:213], v[152:153]
    v_pk_fma_f32 v[214:215], v[152:153], v[152:153], v[214:215]
    v_pk_add_f32 v[212:213], v[212:213], v[154:155]
    v_pk_fma_f32 v[214:215], v[154:155], v[154:155], v[214:215]
    v_add_f32 v212, v212, v213
    v_add_f32 v213, v214, v215
    ds_write_b64 v239, v[212:213]
    s_waitcnt lgkmcnt(0)
    s_barrier
    buffer_load_dword v6, v5, s[16:19], 0 offen sc0 sc1
    ds_read_b128 v[188:191], v2 offset:0
    ds_read_b128 v[192:195], v2 offset:512
    ds_read_b128 v[196:199], v2 offset:1024
    s_waitcnt lgkmcnt(2)
    v_pk_add_f32 v[188:189], v[188:189], v[190:191]
    s_waitcnt lgkmcnt(1)
    v_pk_add_f32 v[192:193], v[192:193], v[194:195]
    s_waitcnt lgkmcnt(0)
    v_pk_add_f32 v[196:197], v[196:197], v[198:199]
    v_pk_add_f32 v[188:189], v[188:189], v[192:193]
    v_pk_add_f32 v[188:189], v[188:189], v[196:197]
    v_mul_f32 v188, 0x3baaaaab, v188
    v_mul_f32 v189, 0x3baaaaab, v189
    v_fma_f32 v189, -v188, v188, v189
    v_max_f32 v189, 0, v189
    v_add_f32 v189, 0x3727c5ac, v189
    v_rsq_f32 v192, v189
    s_nop 0
    v_mul_f32 v193, -v188, v192
    v_pk_fma_f32 v[124:125], v[124:125], v[192:193], v[192:193] op_sel:[0,0,1] op_sel_hi:[1,0,1]
    v_pk_fma_f32 v[126:127], v[126:127], v[192:193], v[192:193] op_sel:[0,0,1] op_sel_hi:[1,0,1]
    v_pk_fma_f32 v[128:129], v[128:129], v[192:193], v[192:193] op_sel:[0,0,1] op_sel_hi:[1,0,1]
    v_pk_fma_f32 v[130:131], v[130:131], v[192:193], v[192:193] op_sel:[0,0,1] op_sel_hi:[1,0,1]
    v_cvt_pk_bf16_f32 v172, v124, v125
    v_cvt_pk_bf16_f32 v173, v126, v127
    v_cvt_pk_bf16_f32 v174, v128, v129
    v_cvt_pk_bf16_f32 v175, v130, v131
    buffer_store_dwordx4 v[172:175], v240, s[16:19], 0 offen offset:0 sc1
    v_pk_fma_f32 v[132:133], v[132:133], v[192:193], v[192:193] op_sel:[0,0,1] op_sel_hi:[1,0,1]
    v_pk_fma_f32 v[134:135], v[134:135], v[192:193], v[192:193] op_sel:[0,0,1] op_sel_hi:[1,0,1]
    v_pk_fma_f32 v[136:137], v[136:137], v[192:193], v[192:193] op_sel:[0,0,1] op_sel_hi:[1,0,1]
    v_pk_fma_f32 v[138:139], v[138:139], v[192:193], v[192:193] op_sel:[0,0,1] op_sel_hi:[1,0,1]
    v_cvt_pk_bf16_f32 v176, v132, v133
    v_cvt_pk_bf16_f32 v177, v134, v135
    v_cvt_pk_bf16_f32 v178, v136, v137
    v_cvt_pk_bf16_f32 v179, v138, v139
    buffer_store_dwordx4 v[176:179], v241, s[16:19], 0 offen offset:1024 sc1
    v_pk_fma_f32 v[140:141], v[140:141], v[192:193], v[192:193] op_sel:[0,0,1] op_sel_hi:[1,0,1]
    v_pk_fma_f32 v[142:143], v[142:143], v[192:193], v[192:193] op_sel:[0,0,1] op_sel_hi:[1,0,1]
    v_pk_fma_f32 v[144:145], v[144:145], v[192:193], v[192:193] op_sel:[0,0,1] op_sel_hi:[1,0,1]
    v_pk_fma_f32 v[146:147], v[146:147], v[192:193], v[192:193] op_sel:[0,0,1] op_sel_hi:[1,0,1]
    v_cvt_pk_bf16_f32 v180, v140, v141
    v_cvt_pk_bf16_f32 v181, v142, v143
    v_cvt_pk_bf16_f32 v182, v144, v145
    v_cvt_pk_bf16_f32 v183, v146, v147
    buffer_store_dwordx4 v[180:183], v240, s[16:19], 0 offen offset:2048 sc1
    v_pk_fma_f32 v[148:149], v[148:149], v[192:193], v[192:193] op_sel:[0,0,1] op_sel_hi:[1,0,1]
    v_pk_fma_f32 v[150:151], v[150:151], v[192:193], v[192:193] op_sel:[0,0,1] op_sel_hi:[1,0,1]
    v_pk_fma_f32 v[152:153], v[152:153], v[192:193], v[192:193] op_sel:[0,0,1] op_sel_hi:[1,0,1]
    v_pk_fma_f32 v[154:155], v[154:155], v[192:193], v[192:193] op_sel:[0,0,1] op_sel_hi:[1,0,1]
    v_cvt_pk_bf16_f32 v184, v148, v149
    v_cvt_pk_bf16_f32 v185, v150, v151
    v_cvt_pk_bf16_f32 v186, v152, v153
    v_cvt_pk_bf16_f32 v187, v154, v155
    buffer_store_dwordx4 v[184:187], v241, s[16:19], 0 offen offset:3072 sc1
    s_mul_i32 s69, s3, 18432
    s_mul_i32 s47, s3, 36864
    s_mov_b32 s44, 0
    s_mov_b32 s45, -1
    s_and_b32 s30, s2, 7
    s_lshr_b32 s31, s2, 3
    s_mul_i32 s32, s30, 282624
    s_add_u32 s64, s32, 270336
    s_add_u32 s35, s31, s3
    s_add_u32 s33, s35, 0
    s_sub_u32 s34, s33, 23
    s_min_u32 s33, s33, s34
    s_mul_i32 s33, s33, 12288
    s_add_u32 s50, s33, s32
    s_add_u32 s33, s35, 4
    s_sub_u32 s34, s33, 23
    s_min_u32 s33, s33, s34
    s_mul_i32 s33, s33, 12288
    s_add_u32 s51, s33, s32
    s_add_u32 s33, s35, 8
    s_sub_u32 s34, s33, 23
    s_min_u32 s33, s33, s34
    s_mul_i32 s33, s33, 12288
    s_add_u32 s52, s33, s32
    s_add_u32 s33, s35, 12
    s_sub_u32 s34, s33, 23
    s_min_u32 s33, s33, s34
    s_mul_i32 s33, s33, 12288
    s_add_u32 s53, s33, s32
    s_add_u32 s33, s35, 16
    s_sub_u32 s34, s33, 23
    s_min_u32 s33, s33, s34
    s_mul_i32 s33, s33, 12288
    s_add_u32 s54, s33, s32
    s_add_u32 s33, s35, 20
    s_sub_u32 s34, s33, 23
    s_min_u32 s33, s33, s34
    s_mul_i32 s33, s33, 12288
    s_add_u32 s55, s33, s32
    s_cmp_eq_u32 s3, 3
    s_cselect_b32 s36, 5242880, 0
    s_add_u32 s33, s31, 0
    s_sub_u32 s34, s33, 23
    s_min_u32 s33, s33, s34
    s_mul_i32 s33, s33, 12288
    s_add_u32 s56, s33, s32
    s_add_u32 s33, s3, 0
    s_and_b32 s33, s33, 3
    s_mul_i32 s60, s33, 3072
    v_add_u32 v21, s60, v1
    v_add_u32 v25, s36, v21
    v_add_u32 v33, 147456, v21
    s_add_u32 s33, s31, 1
    s_sub_u32 s34, s33, 23
    s_min_u32 s33, s33, s34
    s_mul_i32 s33, s33, 12288
    s_add_u32 s57, s33, s32
    s_add_u32 s33, s3, 1
    s_and_b32 s33, s33, 3
    s_mul_i32 s61, s33, 3072
    v_add_u32 v22, s61, v1
    v_add_u32 v26, s36, v22
    v_add_u32 v34, 147456, v22
    s_add_u32 s33, s31, 2
    s_sub_u32 s34, s33, 23
    s_min_u32 s33, s33, s34
    s_mul_i32 s33, s33, 12288
    s_add_u32 s58, s33, s32
    s_add_u32 s33, s3, 2
    s_and_b32 s33, s33, 3
    s_mul_i32 s62, s33, 3072
    v_add_u32 v23, s62, v1
    v_add_u32 v27, s36, v23
    v_add_u32 v35, 147456, v23
    s_add_u32 s33, s31, 3
    s_sub_u32 s34, s33, 23
    s_min_u32 s33, s33, s34
    s_mul_i32 s33, s33, 12288
    s_add_u32 s59, s33, s32
    s_add_u32 s33, s3, 3
    s_and_b32 s33, s33, 3
    s_mul_i32 s63, s33, 3072
    v_add_u32 v24, s63, v1
    v_add_u32 v28, s36, v24
    v_add_u32 v36, 147456, v24
    s_waitcnt vmcnt(4)
    s_branch L_join
L_pre:
    v_subrev_u32 v221, 384, v221
    v_subrev_u32 v222, 384, v222
    v_subrev_u32 v223, 384, v223
    v_subrev_u32 v224, 384, v224
    s_waitcnt vmcnt(0)
    s_branch L_back
L_helper:
    s_waitcnt lgkmcnt(0)
    s_barrier
    s_mov_b32 m0, 8192
    s_mov_b32 s46, 73728
    buffer_load_dwordx4 v221, s[8:11], s46 offen offset:0 lds
    buffer_load_dwordx4 v222, s[8:11], s46 offen offset:1024 lds
    buffer_load_dwordx4 v223, s[8:11], s46 offen offset:2048 lds
    buffer_load_dwordx4 v224, s[8:11], s46 offen offset:3072 lds
    s_mov_b32 m0, 45056
    s_mov_b32 s46, 73856
    buffer_load_dwordx4 v221, s[8:11], s46 offen offset:0 lds
    buffer_load_dwordx4 v222, s[8:11], s46 offen offset:1024 lds
    buffer_load_dwordx4 v223, s[8:11], s46 offen offset:2048 lds
    buffer_load_dwordx4 v224, s[8:11], s46 offen offset:3072 lds
    s_mov_b32 m0, 81920
    s_mov_b32 s46, 73984
    buffer_load_dwordx4 v221, s[8:11], s46 offen offset:0 lds
    buffer_load_dwordx4 v222, s[8:11], s46 offen offset:1024 lds
    buffer_load_dwordx4 v223, s[8:11], s46 offen offset:2048 lds
    buffer_load_dwordx4 v224, s[8:11], s46 offen offset:3072 lds
    s_mov_b32 m0, 12288
    s_mov_b32 s46, 110592
    buffer_load_dwordx4 v221, s[8:11], s46 offen offset:0 lds
    buffer_load_dwordx4 v222, s[8:11], s46 offen offset:1024 lds
    buffer_load_dwordx4 v223, s[8:11], s46 offen offset:2048 lds
    buffer_load_dwordx4 v224, s[8:11], s46 offen offset:3072 lds
    s_mov_b32 m0, 49152
    s_mov_b32 s46, 110720
    buffer_load_dwordx4 v221, s[8:11], s46 offen offset:0 lds
    buffer_load_dwordx4 v222, s[8:11], s46 offen offset:1024 lds
    buffer_load_dwordx4 v223, s[8:11], s46 offen offset:2048 lds
    buffer_load_dwordx4 v224, s[8:11], s46 offen offset:3072 lds
    s_mov_b32 m0, 86016
    s_mov_b32 s46, 110848
    buffer_load_dwordx4 v221, s[8:11], s46 offen offset:0 lds
    buffer_load_dwordx4 v222, s[8:11], s46 offen offset:1024 lds
    buffer_load_dwordx4 v223, s[8:11], s46 offen offset:2048 lds
    buffer_load_dwordx4 v224, s[8:11], s46 offen offset:3072 lds
    s_waitcnt vmcnt(12)
    s_barrier
    s_mov_b32 m0, 16384
    s_mov_b32 s46, 147456
    buffer_load_dwordx4 v221, s[8:11], s46 offen offset:0 lds
    buffer_load_dwordx4 v222, s[8:11], s46 offen offset:1024 lds
    buffer_load_dwordx4 v223, s[8:11], s46 offen offset:2048 lds
    buffer_load_dwordx4 v224, s[8:11], s46 offen offset:3072 lds
    s_mov_b32 m0, 53248
    s_mov_b32 s46, 147584
    buffer_load_dwordx4 v221, s[8:11], s46 offen offset:0 lds
    buffer_load_dwordx4 v222, s[8:11], s46 offen offset:1024 lds
    buffer_load_dwordx4 v223, s[8:11], s46 offen offset:2048 lds
    buffer_load_dwordx4 v224, s[8:11], s46 offen offset:3072 lds
    s_mov_b32 m0, 90112
    s_mov_b32 s46, 147712
    buffer_load_dwordx4 v221, s[8:11], s46 offen offset:0 lds
    buffer_load_dwordx4 v222, s[8:11], s46 offen offset:1024 lds
    buffer_load_dwordx4 v223, s[8:11], s46 offen offset:2048 lds
    buffer_load_dwordx4 v224, s[8:11], s46 offen offset:3072 lds
    s_mov_b32 m0, 20480
    s_mov_b32 s46, 184320
    buffer_load_dwordx4 v221, s[8:11], s46 offen offset:0 lds
    buffer_load_dwordx4 v222, s[8:11], s46 offen offset:1024 lds
    buffer_load_dwordx4 v223, s[8:11], s46 offen offset:2048 lds
    buffer_load_dwordx4 v224, s[8:11], s46 offen offset:3072 lds
    s_mov_b32 m0, 57344
    s_mov_b32 s46, 184448
    buffer_load_dwordx4 v221, s[8:11], s46 offen offset:0 lds
    buffer_load_dwordx4 v222, s[8:11], s46 offen offset:1024 lds
    buffer_load_dwordx4 v223, s[8:11], s46 offen offset:2048 lds
    buffer_load_dwordx4 v224, s[8:11], s46 offen offset:3072 lds
    s_mov_b32 m0, 94208
    s_mov_b32 s46, 184576
    buffer_load_dwordx4 v221, s[8:11], s46 offen offset:0 lds
    buffer_load_dwordx4 v222, s[8:11], s46 offen offset:1024 lds
    buffer_load_dwordx4 v223, s[8:11], s46 offen offset:2048 lds
    buffer_load_dwordx4 v224, s[8:11], s46 offen offset:3072 lds
    s_waitcnt vmcnt(24)
    s_barrier
    s_mov_b32 m0, 24576
    s_mov_b32 s46, 384
    buffer_load_dwordx4 v221, s[8:11], s46 offen offset:0 lds
    buffer_load_dwordx4 v222, s[8:11], s46 offen offset:1024 lds
    buffer_load_dwordx4 v223, s[8:11], s46 offen offset:2048 lds
    buffer_load_dwordx4 v224, s[8:11], s46 offen offset:3072 lds
    s_mov_b32 m0, 61440
    s_mov_b32 s46, 512
    buffer_load_dwordx4 v221, s[8:11], s46 offen offset:0 lds
    buffer_load_dwordx4 v222, s[8:11], s46 offen offset:1024 lds
    buffer_load_dwordx4 v223, s[8:11], s46 offen offset:2048 lds
    buffer_load_dwordx4 v224, s[8:11], s46 offen offset:3072 lds
    s_mov_b32 m0, 98304
    s_mov_b32 s46, 640
    buffer_load_dwordx4 v221, s[8:11], s46 offen offset:0 lds
    buffer_load_dwordx4 v222, s[8:11], s46 offen offset:1024 lds
    buffer_load_dwordx4 v223, s[8:11], s46 offen offset:2048 lds
    buffer_load_dwordx4 v224, s[8:11], s46 offen offset:3072 lds
    s_waitcnt vmcnt(24)
    s_barrier
    s_mov_b32 m0, 28672
    s_mov_b32 s46, 37248
    buffer_load_dwordx4 v221, s[8:11], s46 offen offset:0 lds
    buffer_load_dwordx4 v222, s[8:11], s46 offen offset:1024 lds
    buffer_load_dwordx4 v223, s[8:11], s46 offen offset:2048 lds
    buffer_load_dwordx4 v224, s[8:11], s46 offen offset:3072 lds
    s_mov_b32 m0, 65536
    s_mov_b32 s46, 37376
    buffer_load_dwordx4 v221, s[8:11], s46 offen offset:0 lds
    buffer_load_dwordx4 v222, s[8:11], s46 offen offset:1024 lds
    buffer_load_dwordx4 v223, s[8:11], s46 offen offset:2048 lds
    buffer_load_dwordx4 v224, s[8:11], s46 offen offset:3072 lds
    s_mov_b32 m0, 102400
    s_mov_b32 s46, 37504
    buffer_load_dwordx4 v221, s[8:11], s46 offen offset:0 lds
    buffer_load_dwordx4 v222, s[8:11], s46 offen offset:1024 lds
    buffer_load_dwordx4 v223, s[8:11], s46 offen offset:2048 lds
    buffer_load_dwordx4 v224, s[8:11], s46 offen offset:3072 lds
    s_waitcnt vmcnt(24)
    s_barrier
    s_mov_b32 m0, 32768
    s_mov_b32 s46, 74112
    buffer_load_dwordx4 v221, s[8:11], s46 offen offset:0 lds
    buffer_load_dwordx4 v222, s[8:11], s46 offen offset:1024 lds
    buffer_load_dwordx4 v223, s[8:11], s46 offen offset:2048 lds
    buffer_load_dwordx4 v224, s[8:11], s46 offen offset:3072 lds
    s_mov_b32 m0, 69632
    s_mov_b32 s46, 74240
    buffer_load_dwordx4 v221, s[8:11], s46 offen offset:0 lds
    buffer_load_dwordx4 v222, s[8:11], s46 offen offset:1024 lds
    buffer_load_dwordx4 v223, s[8:11], s46 offen offset:2048 lds
    buffer_load_dwordx4 v224, s[8:11], s46 offen offset:3072 lds
    s_mov_b32 m0, 106496
    s_mov_b32 s46, 74368
    buffer_load_dwordx4 v221, s[8:11], s46 offen offset:0 lds
    buffer_load_dwordx4 v222, s[8:11], s46 offen offset:1024 lds
    buffer_load_dwordx4 v223, s[8:11], s46 offen offset:2048 lds
    buffer_load_dwordx4 v224, s[8:11], s46 offen offset:3072 lds
    s_waitcnt vmcnt(24)
    s_barrier
    s_mov_b32 m0, 0
    s_mov_b32 s46, 110976
    buffer_load_dwordx4 v221, s[8:11], s46 offen offset:0 lds
    buffer_load_dwordx4 v222, s[8:11], s46 offen offset:1024 lds
    buffer_load_dwordx4 v223, s[8:11], s46 offen offset:2048 lds
    buffer_load_dwordx4 v224, s[8:11], s46 offen offset:3072 lds
    s_mov_b32 m0, 36864
    s_mov_b32 s46, 111104
    buffer_load_dwordx4 v221, s[8:11], s46 offen offset:0 lds
    buffer_load_dwordx4 v222, s[8:11], s46 offen offset:1024 lds
    buffer_load_dwordx4 v223, s[8:11], s46 offen offset:2048 lds
    buffer_load_dwordx4 v224, s[8:11], s46 offen offset:3072 lds
    s_mov_b32 m0, 73728
    s_mov_b32 s46, 111232
    buffer_load_dwordx4 v221, s[8:11], s46 offen offset:0 lds
    buffer_load_dwordx4 v222, s[8:11], s46 offen offset:1024 lds
    buffer_load_dwordx4 v223, s[8:11], s46 offen offset:2048 lds
    buffer_load_dwordx4 v224, s[8:11], s46 offen offset:3072 lds
    s_waitcnt vmcnt(24)
    s_barrier
    s_mov_b32 m0, 4096
    s_mov_b32 s46, 147840
    buffer_load_dwordx4 v221, s[8:11], s46 offen offset:0 lds
    buffer_load_dwordx4 v222, s[8:11], s46 offen offset:1024 lds
    buffer_load_dwordx4 v223, s[8:11], s46 offen offset:2048 lds
    buffer_load_dwordx4 v224, s[8:11], s46 offen offset:3072 lds
    s_mov_b32 m0, 40960
    s_mov_b32 s46, 147968
    buffer_load_dwordx4 v221, s[8:11], s46 offen offset:0 lds
    buffer_load_dwordx4 v222, s[8:11], s46 offen offset:1024 lds
    buffer_load_dwordx4 v223, s[8:11], s46 offen offset:2048 lds
    buffer_load_dwordx4 v224, s[8:11], s46 offen offset:3072 lds
    s_mov_b32 m0, 77824
    s_mov_b32 s46, 148096
    buffer_load_dwordx4 v221, s[8:11], s46 offen offset:0 lds
    buffer_load_dwordx4 v222, s[8:11], s46 offen offset:1024 lds
    buffer_load_dwordx4 v223, s[8:11], s46 offen offset:2048 lds
    buffer_load_dwordx4 v224, s[8:11], s46 offen offset:3072 lds
    s_waitcnt vmcnt(24)
    s_barrier
    s_mov_b32 m0, 8192
    s_mov_b32 s46, 184704
    buffer_load_dwordx4 v221, s[8:11], s46 offen offset:0 lds
    buffer_load_dwordx4 v222, s[8:11], s46 offen offset:1024 lds
    buffer_load_dwordx4 v223, s[8:11], s46 offen offset:2048 lds
    buffer_load_dwordx4 v224, s[8:11], s46 offen offset:3072 lds
    s_mov_b32 m0, 45056
    s_mov_b32 s46, 184832
    buffer_load_dwordx4 v221, s[8:11], s46 offen offset:0 lds
    buffer_load_dwordx4 v222, s[8:11], s46 offen offset:1024 lds
    buffer_load_dwordx4 v223, s[8:11], s46 offen offset:2048 lds
    buffer_load_dwordx4 v224, s[8:11], s46 offen offset:3072 lds
    s_mov_b32 m0, 81920
    s_mov_b32 s46, 184960
    buffer_load_dwordx4 v221, s[8:11], s46 offen offset:0 lds
    buffer_load_dwordx4 v222, s[8:11], s46 offen offset:1024 lds
    buffer_load_dwordx4 v223, s[8:11], s46 offen offset:2048 lds
    buffer_load_dwordx4 v224, s[8:11], s46 offen offset:3072 lds
    s_waitcnt vmcnt(24)
    s_barrier
    s_mov_b32 m0, 12288
    s_mov_b32 s46, 768
    buffer_load_dwordx4 v221, s[8:11], s46 offen offset:0 lds
    buffer_load_dwordx4 v222, s[8:11], s46 offen offset:1024 lds
    buffer_load_dwordx4 v223, s[8:11], s46 offen offset:2048 lds
    buffer_load_dwordx4 v224, s[8:11], s46 offen offset:3072 lds
    s_mov_b32 m0, 49152
    s_mov_b32 s46, 896
    buffer_load_dwordx4 v221, s[8:11], s46 offen offset:0 lds
    buffer_load_dwordx4 v222, s[8:11], s46 offen offset:1024 lds
    buffer_load_dwordx4 v223, s[8:11], s46 offen offset:2048 lds
    buffer_load_dwordx4 v224, s[8:11], s46 offen offset:3072 lds
    s_mov_b32 m0, 86016
    s_mov_b32 s46, 1024
    buffer_load_dwordx4 v221, s[8:11], s46 offen offset:0 lds
    buffer_load_dwordx4 v222, s[8:11], s46 offen offset:1024 lds
    buffer_load_dwordx4 v223, s[8:11], s46 offen offset:2048 lds
    buffer_load_dwordx4 v224, s[8:11], s46 offen offset:3072 lds
    s_waitcnt vmcnt(24)
    s_barrier
    s_mov_b32 m0, 16384
    s_mov_b32 s46, 37632
    buffer_load_dwordx4 v221, s[8:11], s46 offen offset:0 lds
    buffer_load_dwordx4 v222, s[8:11], s46 offen offset:1024 lds
    buffer_load_dwordx4 v223, s[8:11], s46 offen offset:2048 lds
    buffer_load_dwordx4 v224, s[8:11], s46 offen offset:3072 lds
    s_mov_b32 m0, 53248
    s_mov_b32 s46, 37760
    buffer_load_dwordx4 v221, s[8:11], s46 offen offset:0 lds
    buffer_load_dwordx4 v222, s[8:11], s46 offen offset:1024 lds
    buffer_load_dwordx4 v223, s[8:11], s46 offen offset:2048 lds
    buffer_load_dwordx4 v224, s[8:11], s46 offen offset:3072 lds
    s_mov_b32 m0, 90112
    s_mov_b32 s46, 37888
    buffer_load_dwordx4 v221, s[8:11], s46 offen offset:0 lds
    buffer_load_dwordx4 v222, s[8:11], s46 offen offset:1024 lds
    buffer_load_dwordx4 v223, s[8:11], s46 offen offset:2048 lds
    buffer_load_dwordx4 v224, s[8:11], s46 offen offset:3072 lds
    s_waitcnt vmcnt(24)
    s_barrier
    s_mov_b32 m0, 20480
    s_mov_b32 s46, 74496
    buffer_load_dwordx4 v221, s[8:11], s46 offen offset:0 lds
    buffer_load_dwordx4 v222, s[8:11], s46 offen offset:1024 lds
    buffer_load_dwordx4 v223, s[8:11], s46 offen offset:2048 lds
    buffer_load_dwordx4 v224, s[8:11], s46 offen offset:3072 lds
    s_mov_b32 m0, 57344
    s_mov_b32 s46, 74624
    buffer_load_dwordx4 v221, s[8:11], s46 offen offset:0 lds
    buffer_load_dwordx4 v222, s[8:11], s46 offen offset:1024 lds
    buffer_load_dwordx4 v223, s[8:11], s46 offen offset:2048 lds
    buffer_load_dwordx4 v224, s[8:11], s46 offen offset:3072 lds
    s_mov_b32 m0, 94208
    s_mov_b32 s46, 74752
    buffer_load_dwordx4 v221, s[8:11], s46 offen offset:0 lds
    buffer_load_dwordx4 v222, s[8:11], s46 offen offset:1024 lds
    buffer_load_dwordx4 v223, s[8:11], s46 offen offset:2048 lds
    buffer_load_dwordx4 v224, s[8:11], s46 offen offset:3072 lds
    s_waitcnt vmcnt(24)
    s_barrier
    s_mov_b32 m0, 24576
    s_mov_b32 s46, 111360
    buffer_load_dwordx4 v221, s[8:11], s46 offen offset:0 lds
    buffer_load_dwordx4 v222, s[8:11], s46 offen offset:1024 lds
    buffer_load_dwordx4 v223, s[8:11], s46 offen offset:2048 lds
    buffer_load_dwordx4 v224, s[8:11], s46 offen offset:3072 lds
    s_mov_b32 m0, 61440
    s_mov_b32 s46, 111488
    buffer_load_dwordx4 v221, s[8:11], s46 offen offset:0 lds
    buffer_load_dwordx4 v222, s[8:11], s46 offen offset:1024 lds
    buffer_load_dwordx4 v223, s[8:11], s46 offen offset:2048 lds
    buffer_load_dwordx4 v224, s[8:11], s46 offen offset:3072 lds
    s_mov_b32 m0, 98304
    s_mov_b32 s46, 111616
    buffer_load_dwordx4 v221, s[8:11], s46 offen offset:0 lds
    buffer_load_dwordx4 v222, s[8:11], s46 offen offset:1024 lds
    buffer_load_dwordx4 v223, s[8:11], s46 offen offset:2048 lds
    buffer_load_dwordx4 v224, s[8:11], s46 offen offset:3072 lds
    s_waitcnt vmcnt(24)
    s_barrier
    s_waitcnt vmcnt(12)
    s_barrier
    s_mov_b32 m0, 28672
    s_mov_b32 s46, 148224
    buffer_load_dwordx4 v221, s[8:11], s46 offen offset:0 lds
    buffer_load_dwordx4 v222, s[8:11], s46 offen offset:1024 lds
    buffer_load_dwordx4 v223, s[8:11], s46 offen offset:2048 lds
    buffer_load_dwordx4 v224, s[8:11], s46 offen offset:3072 lds
    s_mov_b32 m0, 65536
    s_mov_b32 s46, 148352
    buffer_load_dwordx4 v221, s[8:11], s46 offen offset:0 lds
    buffer_load_dwordx4 v222, s[8:11], s46 offen offset:1024 lds
    buffer_load_dwordx4 v223, s[8:11], s46 offen offset:2048 lds
    buffer_load_dwordx4 v224, s[8:11], s46 offen offset:3072 lds
    s_mov_b32 m0, 102400
    s_mov_b32 s46, 148480
    buffer_load_dwordx4 v221, s[8:11], s46 offen offset:0 lds
    buffer_load_dwordx4 v222, s[8:11], s46 offen offset:1024 lds
    buffer_load_dwordx4 v223, s[8:11], s46 offen offset:2048 lds
    buffer_load_dwordx4 v224, s[8:11], s46 offen offset:3072 lds
    s_waitcnt vmcnt(12)
    s_barrier
    s_mov_b32 m0, 32768
    s_mov_b32 s46, 185088
    buffer_load_dwordx4 v221, s[8:11], s46 offen offset:0 lds
    buffer_load_dwordx4 v222, s[8:11], s46 offen offset:1024 lds
    buffer_load_dwordx4 v223, s[8:11], s46 offen offset:2048 lds
    buffer_load_dwordx4 v224, s[8:11], s46 offen offset:3072 lds
    s_mov_b32 m0, 69632
    s_mov_b32 s46, 185216
    buffer_load_dwordx4 v221, s[8:11], s46 offen offset:0 lds
    buffer_load_dwordx4 v222, s[8:11], s46 offen offset:1024 lds
    buffer_load_dwordx4 v223, s[8:11], s46 offen offset:2048 lds
    buffer_load_dwordx4 v224, s[8:11], s46 offen offset:3072 lds
    s_mov_b32 m0, 106496
    s_mov_b32 s46, 185344
    buffer_load_dwordx4 v221, s[8:11], s46 offen offset:0 lds
    buffer_load_dwordx4 v222, s[8:11], s46 offen offset:1024 lds
    buffer_load_dwordx4 v223, s[8:11], s46 offen offset:2048 lds
    buffer_load_dwordx4 v224, s[8:11], s46 offen offset:3072 lds
    s_waitcnt vmcnt(12)
    s_barrier
    s_mov_b32 m0, 0
    s_mov_b32 s46, 0
    buffer_load_dwordx4 v225, s[12:15], s46 offen offset:0 lds
    buffer_load_dwordx4 v226, s[12:15], s46 offen offset:1024 lds
    buffer_load_dwordx4 v227, s[12:15], s46 offen offset:2048 lds
    buffer_load_dwordx4 v228, s[12:15], s46 offen offset:3072 lds
    s_mov_b32 m0, 36864
    s_mov_b32 s46, 24704
    buffer_load_dwordx4 v225, s[12:15], s46 offen offset:0 lds
    buffer_load_dwordx4 v226, s[12:15], s46 offen offset:1024 lds
    buffer_load_dwordx4 v227, s[12:15], s46 offen offset:2048 lds
    buffer_load_dwordx4 v228, s[12:15], s46 offen offset:3072 lds
    s_mov_b32 m0, 73728
    s_mov_b32 s46, 49408
    buffer_load_dwordx4 v225, s[12:15], s46 offen offset:0 lds
    buffer_load_dwordx4 v226, s[12:15], s46 offen offset:1024 lds
    buffer_load_dwordx4 v227, s[12:15], s46 offen offset:2048 lds
    buffer_load_dwordx4 v228, s[12:15], s46 offen offset:3072 lds
    s_waitcnt vmcnt(12)
    s_barrier
    s_mov_b32 m0, 4096
    s_mov_b32 s46, 12288
    buffer_load_dwordx4 v225, s[12:15], s46 offen offset:0 lds
    buffer_load_dwordx4 v226, s[12:15], s46 offen offset:1024 lds
    buffer_load_dwordx4 v227, s[12:15], s46 offen offset:2048 lds
    buffer_load_dwordx4 v228, s[12:15], s46 offen offset:3072 lds
    s_mov_b32 m0, 40960
    s_mov_b32 s46, 36992
    buffer_load_dwordx4 v225, s[12:15], s46 offen offset:0 lds
    buffer_load_dwordx4 v226, s[12:15], s46 offen offset:1024 lds
    buffer_load_dwordx4 v227, s[12:15], s46 offen offset:2048 lds
    buffer_load_dwordx4 v228, s[12:15], s46 offen offset:3072 lds
    s_mov_b32 m0, 77824
    s_mov_b32 s46, 61696
    buffer_load_dwordx4 v225, s[12:15], s46 offen offset:0 lds
    buffer_load_dwordx4 v226, s[12:15], s46 offen offset:1024 lds
    buffer_load_dwordx4 v227, s[12:15], s46 offen offset:2048 lds
    buffer_load_dwordx4 v228, s[12:15], s46 offen offset:3072 lds
    s_mov_b32 m0, 8192
    s_mov_b32 s46, 24576
    buffer_load_dwordx4 v225, s[12:15], s46 offen offset:0 lds
    buffer_load_dwordx4 v226, s[12:15], s46 offen offset:1024 lds
    buffer_load_dwordx4 v227, s[12:15], s46 offen offset:2048 lds
    buffer_load_dwordx4 v228, s[12:15], s46 offen offset:3072 lds
    s_mov_b32 m0, 45056
    s_mov_b32 s46, 49280
    buffer_load_dwordx4 v225, s[12:15], s46 offen offset:0 lds
    buffer_load_dwordx4 v226, s[12:15], s46 offen offset:1024 lds
    buffer_load_dwordx4 v227, s[12:15], s46 offen offset:2048 lds
    buffer_load_dwordx4 v228, s[12:15], s46 offen offset:3072 lds
    s_mov_b32 m0, 81920
    s_mov_b32 s46, 256
    buffer_load_dwordx4 v225, s[12:15], s46 offen offset:0 lds
    buffer_load_dwordx4 v226, s[12:15], s46 offen offset:1024 lds
    buffer_load_dwordx4 v227, s[12:15], s46 offen offset:2048 lds
    buffer_load_dwordx4 v228, s[12:15], s46 offen offset:3072 lds
    s_mov_b32 m0, 12288
    s_mov_b32 s46, 36864
    buffer_load_dwordx4 v225, s[12:15], s46 offen offset:0 lds
    buffer_load_dwordx4 v226, s[12:15], s46 offen offset:1024 lds
    buffer_load_dwordx4 v227, s[12:15], s46 offen offset:2048 lds
    buffer_load_dwordx4 v228, s[12:15], s46 offen offset:3072 lds
    s_mov_b32 m0, 49152
    s_mov_b32 s46, 61568
    buffer_load_dwordx4 v225, s[12:15], s46 offen offset:0 lds
    buffer_load_dwordx4 v226, s[12:15], s46 offen offset:1024 lds
    buffer_load_dwordx4 v227, s[12:15], s46 offen offset:2048 lds
    buffer_load_dwordx4 v228, s[12:15], s46 offen offset:3072 lds
    s_mov_b32 m0, 86016
    s_mov_b32 s46, 12544
    buffer_load_dwordx4 v225, s[12:15], s46 offen offset:0 lds
    buffer_load_dwordx4 v226, s[12:15], s46 offen offset:1024 lds
    buffer_load_dwordx4 v227, s[12:15], s46 offen offset:2048 lds
    buffer_load_dwordx4 v228, s[12:15], s46 offen offset:3072 lds
    s_waitcnt vmcnt(36)
    s_barrier
    s_waitcnt vmcnt(24)
    s_barrier
    s_waitcnt vmcnt(12)
    s_barrier
    s_mov_b32 m0, 16384
    s_mov_b32 s46, 49152
    buffer_load_dwordx4 v225, s[12:15], s46 offen offset:0 lds
    buffer_load_dwordx4 v226, s[12:15], s46 offen offset:1024 lds
    buffer_load_dwordx4 v227, s[12:15], s46 offen offset:2048 lds
    buffer_load_dwordx4 v228, s[12:15], s46 offen offset:3072 lds
    s_mov_b32 m0, 53248
    s_mov_b32 s46, 128
    buffer_load_dwordx4 v225, s[12:15], s46 offen offset:0 lds
    buffer_load_dwordx4 v226, s[12:15], s46 offen offset:1024 lds
    buffer_load_dwordx4 v227, s[12:15], s46 offen offset:2048 lds
    buffer_load_dwordx4 v228, s[12:15], s46 offen offset:3072 lds
    s_mov_b32 m0, 90112
    s_mov_b32 s46, 24832
    buffer_load_dwordx4 v225, s[12:15], s46 offen offset:0 lds
    buffer_load_dwordx4 v226, s[12:15], s46 offen offset:1024 lds
    buffer_load_dwordx4 v227, s[12:15], s46 offen offset:2048 lds
    buffer_load_dwordx4 v228, s[12:15], s46 offen offset:3072 lds
    s_mov_b32 m0, 20480
    s_mov_b32 s46, 61440
    buffer_load_dwordx4 v225, s[12:15], s46 offen offset:0 lds
    buffer_load_dwordx4 v226, s[12:15], s46 offen offset:1024 lds
    buffer_load_dwordx4 v227, s[12:15], s46 offen offset:2048 lds
    buffer_load_dwordx4 v228, s[12:15], s46 offen offset:3072 lds
    s_mov_b32 m0, 57344
    s_mov_b32 s46, 12416
    buffer_load_dwordx4 v225, s[12:15], s46 offen offset:0 lds
    buffer_load_dwordx4 v226, s[12:15], s46 offen offset:1024 lds
    buffer_load_dwordx4 v227, s[12:15], s46 offen offset:2048 lds
    buffer_load_dwordx4 v228, s[12:15], s46 offen offset:3072 lds
    s_mov_b32 m0, 94208
    s_mov_b32 s46, 37120
    buffer_load_dwordx4 v225, s[12:15], s46 offen offset:0 lds
    buffer_load_dwordx4 v226, s[12:15], s46 offen offset:1024 lds
    buffer_load_dwordx4 v227, s[12:15], s46 offen offset:2048 lds
    buffer_load_dwordx4 v228, s[12:15], s46 offen offset:3072 lds
    s_waitcnt vmcnt(24)
    s_barrier
    v_lshrrev_b32 v7, 2, v0
    v_mul_u32_u24 v7, 5888, v7
    v_and_b32 v8, 3, v0
    v_lshl_add_u32 v7, v8, 3, v7
    s_lshl_b32 s28, s2, 5
    s_add_u32 s28, s28, 2097152
    v_add_u32 v4, s28, v7
    s_waitcnt vmcnt(12)
    s_barrier
    s_waitcnt vmcnt(0)
    s_barrier
    v_lshlrev_b32 v8, 2, v0
    s_mov_b64 exec, 0xff
    s_mov_b32 s68, 0
L_pollD:
    s_sleep 2
    buffer_load_dword v7, v8, s[24:27], 0 offen sc0 sc1
    s_add_u32 s68, s68, 1
    s_cmp_gt_u32 s68, 1048576
    s_waitcnt vmcnt(0)
    s_cbranch_scc1 L_pollD_out
    v_cmp_ne_u32 vcc, 1, v7
    s_nop 0
    s_and_b64 exec, exec, vcc
    s_cbranch_execnz L_pollD
L_pollD_out:
    s_mov_b64 exec, -1
    s_barrier
    buffer_load_dword v6, v5, s[16:19], 0 offen sc0 sc1
    ds_read_b128 v[188:191], v2 offset:0
    ds_read_b128 v[192:195], v2 offset:512
    ds_read_b128 v[196:199], v2 offset:1024
    s_waitcnt lgkmcnt(2)
    v_pk_add_f32 v[188:189], v[188:189], v[190:191]
    s_waitcnt lgkmcnt(1)
    v_pk_add_f32 v[192:193], v[192:193], v[194:195]
    s_waitcnt lgkmcnt(0)
    v_pk_add_f32 v[196:197], v[196:197], v[198:199]
    v_pk_add_f32 v[188:189], v[188:189], v[192:193]
    v_pk_add_f32 v[188:189], v[188:189], v[196:197]
    v_mul_f32 v188, 0x3baaaaab, v188
    v_mul_f32 v189, 0x3baaaaab, v189
    v_fma_f32 v189, -v188, v188, v189
    v_max_f32 v189, 0, v189
    v_add_f32 v189, 0x3727c5ac, v189
    v_rsq_f32 v192, v189
    s_nop 0
    v_mul_f32 v193, -v188, v192
    v_mul_f32 v189, v189, v192
    s_mov_b64 exec, 0xfffffff
    buffer_store_dwordx2 v[188:189], v4, s[16:19], 0 offen sc1
    s_mov_b64 exec, -1
    s_mul_i32 s69, s3, 18432
    s_mul_i32 s47, s3, 36864
    s_mov_b32 s44, 0
    s_mov_b32 s45, -1
    s_and_b32 s30, s2, 7
    s_lshr_b32 s31, s2, 3
    s_mul_i32 s32, s30, 282624
    s_add_u32 s64, s32, 270336
    s_add_u32 s35, s31, s3
    s_add_u32 s33, s35, 0
    s_sub_u32 s34, s33, 23
    s_min_u32 s33, s33, s34
    s_mul_i32 s33, s33, 12288
    s_add_u32 s50, s33, s32
    s_add_u32 s33, s35, 4
    s_sub_u32 s34, s33, 23
    s_min_u32 s33, s33, s34
    s_mul_i32 s33, s33, 12288
    s_add_u32 s51, s33, s32
    s_add_u32 s33, s35, 8
    s_sub_u32 s34, s33, 23
    s_min_u32 s33, s33, s34
    s_mul_i32 s33, s33, 12288
    s_add_u32 s52, s33, s32
    s_add_u32 s33, s35, 12
    s_sub_u32 s34, s33, 23
    s_min_u32 s33, s33, s34
    s_mul_i32 s33, s33, 12288
    s_add_u32 s53, s33, s32
    s_add_u32 s33, s35, 16
    s_sub_u32 s34, s33, 23
    s_min_u32 s33, s33, s34
    s_mul_i32 s33, s33, 12288
    s_add_u32 s54, s33, s32
    s_add_u32 s33, s35, 20
    s_sub_u32 s34, s33, 23
    s_min_u32 s33, s33, s34
    s_mul_i32 s33, s33, 12288
    s_add_u32 s55, s33, s32
    s_cmp_eq_u32 s3, 3
    s_cselect_b32 s36, 5242880, 0
    s_add_u32 s33, s31, 0
    s_sub_u32 s34, s33, 23
    s_min_u32 s33, s33, s34
    s_mul_i32 s33, s33, 12288
    s_add_u32 s56, s33, s32
    s_add_u32 s33, s3, 0
    s_and_b32 s33, s33, 3
    s_mul_i32 s60, s33, 3072
    v_add_u32 v21, s60, v1
    v_add_u32 v25, s36, v21
    v_add_u32 v33, 147456, v21
    s_add_u32 s33, s31, 1
    s_sub_u32 s34, s33, 23
    s_min_u32 s33, s33, s34
    s_mul_i32 s33, s33, 12288
    s_add_u32 s57, s33, s32
    s_add_u32 s33, s3, 1
    s_and_b32 s33, s33, 3
    s_mul_i32 s61, s33, 3072
    v_add_u32 v22, s61, v1
    v_add_u32 v26, s36, v22
    v_add_u32 v34, 147456, v22
    s_add_u32 s33, s31, 2
    s_sub_u32 s34, s33, 23
    s_min_u32 s33, s33, s34
    s_mul_i32 s33, s33, 12288
    s_add_u32 s58, s33, s32
    s_add_u32 s33, s3, 2
    s_and_b32 s33, s33, 3
    s_mul_i32 s62, s33, 3072
    v_add_u32 v23, s62, v1
    v_add_u32 v27, s36, v23
    v_add_u32 v35, 147456, v23
    s_add_u32 s33, s31, 3
    s_sub_u32 s34, s33, 23
    s_min_u32 s33, s33, s34
    s_mul_i32 s33, s33, 12288
    s_add_u32 s59, s33, s32
    s_add_u32 s33, s3, 3
    s_and_b32 s33, s33, 3
    s_mul_i32 s63, s33, 3072
    v_add_u32 v24, s63, v1
    v_add_u32 v28, s36, v24
    v_add_u32 v36, 147456, v24
    s_waitcnt vmcnt(1)
L_join:
    v_cmp_ne_u32 vcc, 1, v6
    s_cbranch_vccnz L_waitA
L_haveA:
    s_lshl_b32 s33, s31, 7
    s_lshl_b32 s34, s30, 2
    s_add_u32 s33, s33, s34
    s_add_u32 s33, s33, 2359296
    v_lshl_add_u32 v3, v0, 12, s33
    v_lshrrev_b32 v7, 1, v0
    v_subrev_u32 v8, 3, v7
    v_lshlrev_b32 v8, 2, v8
    v_add_u32 v8, s3, v8
    v_cmp_gt_u32 vcc, 4, v7
    v_and_b32 v9, 1, v0
    v_lshlrev_b32 v9, 4, v9
    v_cndmask_b32 v8, v8, v7, vcc
    v_add_u32 v8, s31, v8
    v_subrev_u32 v10, 23, v8
    v_min_u32 v8, v8, v10
    v_lshl_add_u32 v8, v8, 7, v9
    s_lshl_b32 s33, s30, 12
    s_add_u32 s33, s33, 2359296
    v_add_u32 v20, s33, v8
    s_and_b32 s33, s3, 1
    v_lshrrev_b32 v7, 5, v0
    v_and_b32 v8, 31, v0
    v_and_b32 v11, 3, v0
    v_bfe_u32 v9, v0, 4, 1
    v_bfe_u32 v12, v0, 2, 2
    v_bfe_u32 v17, v0, 3, 1
    v_lshrrev_b32 v10, 2, v8
    v_xor_b32 v10, s33, v10
    v_lshlrev_b32 v10, 7, v10
    v_xor_b32 v13, v17, v7
    v_lshl_add_u32 v10, v13, 6, v10
    v_lshl_add_u32 v10, v11, 4, v10
    v_xor_b32 v13, 128, v10
    v_add_u32 v29, s47, v10
    v_add_u32 v30, s47, v13
    v_xor_b32 v10, v9, v7
    v_xor_b32 v10, s33, v10
    v_lshlrev_b32 v10, 7, v10
    v_lshl_add_u32 v10, v9, 10, v10
    v_bfe_u32 v13, v0, 1, 1
    v_lshl_add_u32 v10, v13, 6, v10
    v_lshl_add_u32 v10, v12, 4, v10
    v_and_b32 v13, 1, v0
    v_lshl_add_u32 v10, v13, 3, v10
    v_xor_b32 v13, 0x140, v10
    v_add_u32 v31, s47, v10
    v_add_u32 v32, s47, v13
    v_xor_b32 v15, v17, v9
    v_xor_b32 v14, v17, v12
    v_xor_b32 v16, v14, v7
    v_lshlrev_b32 v16, 7, v16
    v_lshl_add_u32 v16, v7, 10, v16
    v_lshl_add_u32 v16, v15, 6, v16
    v_lshl_add_u32 v37, v11, 4, v16
    s_mul_i32 s34, s3, 3072
    v_xor_b32 v10, s33, v12
    v_lshlrev_b32 v13, 7, v10
    v_lshl_add_u32 v13, v15, 6, v13
    v_lshl_add_u32 v13, v11, 4, v13
    v_lshl_add_u32 v13, v7, 3, v13
    s_add_u32 s36, s34, 2048
    v_add_u32 v52, s36, v13
    v_xor_b32 v10, v10, v7
    v_lshlrev_b32 v10, 7, v10
    v_lshl_add_u32 v10, v7, 10, v10
    v_lshl_add_u32 v10, v17, 6, v10
    v_lshl_add_u32 v10, v11, 4, v10
    v_lshl_add_u32 v10, v9, 3, v10
    v_add_u32 v50, s34, v10
    v_xor_b32 v51, 64, v50
    v_lshl_add_u32 v15, v14, 2, v11
    s_add_u32 s34, s34, 147456
    v_lshl_add_u32 v15, v15, 4, s34
    v_lshrrev_b32 v16, 4, v0
    v_lshl_add_u32 v38, v16, 9, v15
    v_lshl_add_u32 v15, v7, 9, v15
    v_lshl_add_u32 v15, v9, 3, v15
    v_add_u32 v39, 2048, v15
    v_add_u32 v48, s34, v1
    v_lshlrev_b32 v15, 5, v8
    v_add_u32 v15, 159744, v15
    v_lshl_add_u32 v40, s3, 3, v15
    v_add_u32 v44, s47, v1
    s_add_u32 s34, s3, 3
    s_and_b32 s34, s34, 3
    v_lshl_add_u32 v41, s34, 3, v15
    s_mul_i32 s34, s34, 36864
    s_add_u32 s34, s34, 0
    v_add_u32 v45, s34, v1
    s_add_u32 s34, s3, 2
    s_and_b32 s34, s34, 3
    v_lshl_add_u32 v42, s34, 3, v15
    s_mul_i32 s34, s34, 36864
    s_add_u32 s34, s34, 3072
    v_add_u32 v46, s34, v1
    s_add_u32 s34, s3, 1
    s_and_b32 s34, s34, 3
    v_lshl_add_u32 v43, s34, 3, v15
    s_mul_i32 s34, s34, 36864
    s_add_u32 s34, s34, 6144
    v_add_u32 v47, s34, v1
    v_and_b32 v15, 15, v0
    v_lshlrev_b32 v10, 4, v15
    v_lshl_add_u32 v10, v16, 9, v10
    v_add_u32 v49, 147456, v10
    s_mul_i32 s34, s30, 5888
    s_lshl_b32 s35, s31, 8
    s_add_u32 s34, s34, s35
    s_add_u32 s34, s34, 2097152
    v_lshl_add_u32 v53, v15, 3, s34
    s_mul_i32 s34, s30, 279936
    s_mul_i32 s35, s3, 96
    s_add_u32 s34, s34, s35
    s_lshl_b32 s35, s31, 5
    s_movk_i32 s36, 729
    v_mov_b32 v17, 2031616
    v_add_u32 v10, s35, v15
    v_cmp_gt_u32 vcc, s36, v10
    v_mul_u32_u24 v13, 384, v10
    v_add_u32 v13, s34, v13
    v_cndmask_b32 v13, v17, v13, vcc
    v_lshl_add_u32 v54, v16, 4, v13
    v_lshl_add_u32 v56, v16, 3, v13
    v_add_u32 v10, 16, v10
    v_cmp_gt_u32 vcc, s36, v10
    v_mul_u32_u24 v13, 384, v10
    v_add_u32 v13, s34, v13
    v_cndmask_b32 v13, v17, v13, vcc
    v_lshl_add_u32 v55, v16, 4, v13
    v_lshl_add_u32 v57, v16, 3, v13
    v_mov_b32 v9, 1
    s_waitcnt vmcnt(0)
    s_barrier
    s_cmp_lg_u32 s3, 3
    s_cbranch_scc1 L_noflag
    s_mov_b64 exec, 0x7f
    buffer_store_dword v9, v3, s[16:19], 0 offen sc0 sc1
    s_mov_b64 exec, -1
L_noflag:
    s_and_b32 s28, s2, 7
    s_cmp_eq_u32 s28, 7
    s_cbranch_scc1 L_fin
    s_add_u32 s46, s69, 2162688
    buffer_load_dwordx4 a[48:51], v1, s[16:19], s46 offen offset:0 sc1
    buffer_load_dwordx4 a[52:55], v1, s[16:19], s46 offen offset:1024 sc1
    buffer_load_dwordx4 a[56:59], v1, s[16:19], s46 offen offset:2048 sc1
    buffer_load_dwordx4 a[60:63], v1, s[16:19], s46 offen offset:3072 sc1
    s_add_u32 s46, s69, 2166784
    buffer_load_dwordx4 a[64:67], v1, s[16:19], s46 offen offset:0 sc1
    buffer_load_dwordx4 a[68:71], v1, s[16:19], s46 offen offset:1024 sc1
    buffer_load_dwordx4 a[72:75], v1, s[16:19], s46 offen offset:2048 sc1
    buffer_load_dwordx4 a[76:79], v1, s[16:19], s46 offen offset:3072 sc1
    s_add_u32 s46, s69, 2170880
    buffer_load_dwordx4 a[80:83], v1, s[16:19], s46 offen offset:0 sc1
    buffer_load_dwordx4 a[84:87], v1, s[16:19], s46 offen offset:1024 sc1
    buffer_load_dwordx4 a[88:91], v1, s[16:19], s46 offen offset:2048 sc1
    buffer_load_dwordx4 a[92:95], v1, s[16:19], s46 offen offset:3072 sc1
    s_add_u32 s46, s69, 2174976
    buffer_load_dwordx4 a[96:99], v1, s[16:19], s46 offen offset:0 sc1
    buffer_load_dwordx4 a[100:103], v1, s[16:19], s46 offen offset:1024 sc1
    buffer_load_dwordx4 a[104:107], v1, s[16:19], s46 offen offset:2048 sc1
    buffer_load_dwordx4 a[108:111], v1, s[16:19], s46 offen offset:3072 sc1
    s_add_u32 s46, s69, 2179072
    buffer_load_dwordx4 a[112:115], v1, s[16:19], s46 offen offset:0 sc1
    buffer_load_dwordx4 a[116:119], v1, s[16:19], s46 offen offset:1024 sc1
    s_mov_b64 exec, 0x3ffff
    s_mov_b32 s68, 0
L_pollF:
    buffer_load_dwordx4 v[60:63], v20, s[16:19], 0 offen sc0 sc1
    s_add_u32 s68, s68, 1
    s_cmp_gt_u32 s68, 1048576
    s_waitcnt vmcnt(0)
    s_cbranch_scc1 L_pollF_out
    v_and_b32 v7, v60, v61
    v_bitop3_b32 v7, v7, v62, v63 bitop3:0x80
    v_cmp_ne_u32 vcc, 1, v7
    s_nop 0
    s_and_b64 exec, exec, vcc
    s_cbranch_execnz L_pollF
L_pollF_out:
    s_mov_b64 exec, -1
    s_mul_i32 s28, s3, 3072
    s_add_u32 m0, s28, 0
    s_nop 0
    buffer_load_dwordx4 v21, s[16:19], s56 offen offset:0 sc1 lds
    buffer_load_dwordx4 v21, s[16:19], s56 offen offset:1024 sc1 lds
    buffer_load_dwordx4 v21, s[16:19], s56 offen offset:2048 sc1 lds
    buffer_load_dwordx2 v[112:113], v53, s[16:19], 0 offen offset:0 sc1
    buffer_load_dwordx2 v[114:115], v53, s[16:19], 0 offen offset:128 sc1
    buffer_load_dword v6, v5, s[16:19], 0 offen offset:1152 sc0 sc1
    s_add_u32 m0, s28, 36864
    s_nop 0
    buffer_load_dwordx4 v22, s[16:19], s57 offen offset:0 sc1 lds
    buffer_load_dwordx4 v22, s[16:19], s57 offen offset:1024 sc1 lds
    buffer_load_dwordx4 v22, s[16:19], s57 offen offset:2048 sc1 lds
    s_add_u32 m0, s28, 73728
    s_nop 0
    buffer_load_dwordx4 v23, s[16:19], s58 offen offset:0 sc1 lds
    buffer_load_dwordx4 v23, s[16:19], s58 offen offset:1024 sc1 lds
    buffer_load_dwordx4 v23, s[16:19], s58 offen offset:2048 sc1 lds
    s_add_u32 m0, s28, 110592
    s_nop 0
    buffer_load_dwordx4 v24, s[16:19], s59 offen offset:0 sc1 lds
    buffer_load_dwordx4 v24, s[16:19], s59 offen offset:1024 sc1 lds
    buffer_load_dwordx4 v24, s[16:19], s59 offen offset:2048 sc1 lds
    v_mov_b32 v188, 0
    v_mov_b32 v189, 0
    v_mov_b32 v190, 0
    v_mov_b32 v191, 0
    v_mov_b32 v192, 0
    v_mov_b32 v193, 0
    v_mov_b32 v194, 0
    v_mov_b32 v195, 0
    v_mov_b32 v196, 0
    v_mov_b32 v197, 0
    v_mov_b32 v198, 0
    v_mov_b32 v199, 0
    v_mov_b32 v200, 0
    v_mov_b32 v201, 0
    v_mov_b32 v202, 0
    v_mov_b32 v203, 0
    v_mov_b32 v205, 0xff800000
    v_mov_b32 v206, 0xff800000
    v_mov_b32 v207, 0xff800000
    v_cndmask_b32 v204, 0, v205, s[44:45]
    v_mov_b32 v217, 0
    v_mov_b32 v218, 0
    s_waitcnt vmcnt(12)
    s_barrier
    ds_read_b128 a[0:3], v37 offset:0
    ds_read_b128 a[4:7], v37 offset:2048
    ds_read_b128 a[8:11], v37 offset:4096
    ds_read_b128 a[12:15], v37 offset:6144
    ds_read_b128 a[16:19], v37 offset:8192
    ds_read_b128 a[20:23], v37 offset:10240
    ds_read_b128 a[24:27], v37 offset:512
    ds_read_b128 a[28:31], v37 offset:2560
    ds_read_b128 a[32:35], v37 offset:4608
    ds_read_b128 a[36:39], v37 offset:6656
    ds_read_b128 a[40:43], v37 offset:8704
    ds_read_b128 a[44:47], v37 offset:10752
    s_waitcnt lgkmcnt(11)
    v_mfma_f32_16x16x32_bf16 v[60:63], a[48:51], a[0:3], 0
    s_add_u32 m0, s47, 12288
    s_nop 0
    buffer_load_dwordx4 v21, s[16:19], s51 offen offset:0 sc1 lds
    v_mfma_f32_16x16x32_bf16 v[64:67], a[72:75], a[0:3], 0
    ds_read_b64 v[100:101], v50 offset:0
    v_mfma_f32_16x16x32_bf16 v[68:71], a[96:99], a[0:3], 0
    ds_read_b64 v[102:103], v51 offset:0
    s_waitcnt lgkmcnt(12)
    v_mfma_f32_16x16x32_bf16 v[60:63], a[52:55], a[4:7], v[60:63]
    ds_read_b64 v[104:105], v52 offset:0
    v_mfma_f32_16x16x32_bf16 v[64:67], a[76:79], a[4:7], v[64:67]
    buffer_load_dwordx4 v21, s[16:19], s51 offen offset:1024 sc1 lds
    ds_read_b64 v[106:107], v50 offset:512
    v_mfma_f32_16x16x32_bf16 v[68:71], a[100:103], a[4:7], v[68:71]
    ds_read_b64 v[108:109], v51 offset:512
    s_waitcnt lgkmcnt(14)
    v_mfma_f32_16x16x32_bf16 v[60:63], a[56:59], a[8:11], v[60:63]
    ds_read_b64 v[110:111], v52 offset:512
    v_mfma_f32_16x16x32_bf16 v[64:67], a[80:83], a[8:11], v[64:67]
    v_mfma_f32_16x16x32_bf16 v[68:71], a[104:107], a[8:11], v[68:71]
    s_waitcnt lgkmcnt(14)
    v_mfma_f32_16x16x32_bf16 v[60:63], a[60:63], a[12:15], v[60:63]
    v_mfma_f32_16x16x32_bf16 v[64:67], a[84:87], a[12:15], v[64:67]
    s_waitcnt lgkmcnt(5)
    v_lshlrev_b32 v220, 16, v100
    v_and_b32 v221, 0xffff0000, v100
    v_mfma_f32_16x16x32_bf16 v[68:71], a[108:111], a[12:15], v[68:71]
    s_waitcnt vmcnt(13)
    v_fma_f32 v220, v220, v113, v112
    v_fma_f32 v221, v221, v113, v112
    v_mfma_f32_16x16x32_bf16 v[60:63], a[64:67], a[16:19], v[60:63]
    v_lshlrev_b32 v222, 16, v101
    v_and_b32 v223, 0xffff0000, v101
    v_mfma_f32_16x16x32_bf16 v[64:67], a[88:91], a[16:19], v[64:67]
    v_fma_f32 v222, v222, v113, v112
    v_fma_f32 v223, v223, v113, v112
    v_mfma_f32_16x16x32_bf16 v[68:71], a[112:115], a[16:19], v[68:71]
    s_waitcnt lgkmcnt(4)
    v_lshlrev_b32 v224, 16, v102
    v_and_b32 v225, 0xffff0000, v102
    v_mfma_f32_16x16x32_bf16 v[60:63], a[68:71], a[20:23], v[60:63]
    v_fma_f32 v224, v224, v113, v112
    v_fma_f32 v225, v225, v113, v112
    v_mfma_f32_16x16x32_bf16 v[64:67], a[92:95], a[20:23], v[64:67]
    v_lshlrev_b32 v226, 16, v103
    v_and_b32 v227, 0xffff0000, v103
    v_mfma_f32_16x16x32_bf16 v[68:71], a[116:119], a[20:23], v[68:71]
    v_fma_f32 v226, v226, v113, v112
    v_fma_f32 v227, v227, v113, v112
    v_mfma_f32_16x16x32_bf16 v[72:75], a[48:51], a[24:27], 0
    s_waitcnt lgkmcnt(3)
    v_lshlrev_b32 v228, 16, v104
    v_and_b32 v229, 0xffff0000, v104
    v_mfma_f32_16x16x32_bf16 v[76:79], a[72:75], a[24:27], 0
    v_fma_f32 v228, v228, v113, v112
    v_fma_f32 v229, v229, v113, v112
    v_mfma_f32_16x16x32_bf16 v[80:83], a[96:99], a[24:27], 0
    v_lshlrev_b32 v230, 16, v105
    v_and_b32 v231, 0xffff0000, v105
    v_mfma_f32_16x16x32_bf16 v[72:75], a[52:55], a[28:31], v[72:75]
    v_fma_f32 v230, v230, v113, v112
    v_fma_f32 v231, v231, v113, v112
    v_mfma_f32_16x16x32_bf16 v[76:79], a[76:79], a[28:31], v[76:79]
    v_cvt_pk_bf16_f32 v84, v60, v61
    v_cvt_pk_bf16_f32 v85, v62, v63
    v_mfma_f32_16x16x32_bf16 v[80:83], a[100:103], a[28:31], v[80:83]
    v_cvt_pk_bf16_f32 v86, v64, v65
    v_cvt_pk_bf16_f32 v87, v66, v67
    v_mfma_f32_16x16x32_bf16 v[72:75], a[56:59], a[32:35], v[72:75]
    v_cvt_pk_bf16_f32 v88, v68, v69
    v_cvt_pk_bf16_f32 v89, v70, v71
    v_mfma_f32_16x16x32_bf16 v[76:79], a[80:83], a[32:35], v[76:79]
    s_waitcnt lgkmcnt(2)
    v_lshlrev_b32 v232, 16, v106
    v_and_b32 v233, 0xffff0000, v106
    v_mfma_f32_16x16x32_bf16 v[80:83], a[104:107], a[32:35], v[80:83]
    ds_write_b128 v38, v[84:87] offset:0
    s_waitcnt vmcnt(12)
    v_fma_f32 v232, v232, v115, v114
    v_fma_f32 v233, v233, v115, v114
    v_mfma_f32_16x16x32_bf16 v[72:75], a[60:63], a[36:39], v[72:75]
    v_lshlrev_b32 v234, 16, v107
    v_and_b32 v235, 0xffff0000, v107
    v_mfma_f32_16x16x32_bf16 v[76:79], a[84:87], a[36:39], v[76:79]
    ds_write_b64 v39, v[88:89] offset:0
    v_fma_f32 v234, v234, v115, v114
    v_fma_f32 v235, v235, v115, v114
    v_mfma_f32_16x16x32_bf16 v[80:83], a[108:111], a[36:39], v[80:83]
    s_waitcnt lgkmcnt(3)
    v_lshlrev_b32 v236, 16, v108
    v_and_b32 v237, 0xffff0000, v108
    v_mfma_f32_16x16x32_bf16 v[72:75], a[64:67], a[40:43], v[72:75]
    v_fma_f32 v236, v236, v115, v114
    v_fma_f32 v237, v237, v115, v114
    v_lshlrev_b32 v238, 16, v109
    v_mfma_f32_16x16x32_bf16 v[76:79], a[88:91], a[40:43], v[76:79]
    v_and_b32 v239, 0xffff0000, v109
    v_fma_f32 v238, v238, v115, v114
    v_mfma_f32_16x16x32_bf16 v[80:83], a[112:115], a[40:43], v[80:83]
    v_fma_f32 v239, v239, v115, v114
    s_waitcnt lgkmcnt(2)
    v_lshlrev_b32 v240, 16, v110
    v_mfma_f32_16x16x32_bf16 v[72:75], a[68:71], a[44:47], v[72:75]
    v_and_b32 v241, 0xffff0000, v110
    v_fma_f32 v240, v240, v115, v114
    v_mfma_f32_16x16x32_bf16 v[76:79], a[92:95], a[44:47], v[76:79]
    v_fma_f32 v241, v241, v115, v114
    v_lshlrev_b32 v242, 16, v111
    v_mfma_f32_16x16x32_bf16 v[80:83], a[116:119], a[44:47], v[80:83]
    v_and_b32 v243, 0xffff0000, v111
    v_fma_f32 v242, v242, v115, v114
    v_fma_f32 v243, v243, v115, v114
    v_cvt_pk_bf16_f32 v92, v72, v73
    v_cvt_pk_bf16_f32 v93, v74, v75
    v_cvt_pk_bf16_f32 v94, v76, v77
    v_cvt_pk_bf16_f32 v95, v78, v79
    s_nop 0
    v_cvt_pk_bf16_f32 v96, v80, v81
    v_cvt_pk_bf16_f32 v97, v82, v83
    ds_write_b128 v38, v[92:95] offset:256
    ds_write_b64 v39, v[96:97] offset:256
    buffer_load_dwordx4 v21, s[16:19], s51 offen offset:2048 sc1 lds
    s_add_u32 m0, s47, 15360
    s_nop 0
    buffer_load_dwordx4 v22, s[16:19], s51 offen offset:0 sc1 lds
    buffer_load_dwordx4 v22, s[16:19], s51 offen offset:1024 sc1 lds
    buffer_load_dwordx4 v22, s[16:19], s51 offen offset:2048 sc1 lds
    s_waitcnt vmcnt(6)
    s_waitcnt lgkmcnt(0)
    s_barrier
    ds_read_b128 a[120:123], v33 offset:0
    ds_read_b128 a[168:171], v29 offset:0
    ds_read_b128 a[124:127], v33 offset:1024
    ds_read_b128 a[172:175], v30 offset:1024
    ds_read_b128 a[128:131], v33 offset:2048
    ds_read_b128 a[176:179], v29 offset:2048
    ds_read_b128 a[132:135], v34 offset:0
    ds_read_b128 a[180:183], v30 offset:3072
    ds_read_b128 a[136:139], v34 offset:1024
    ds_read_b128 a[184:187], v29 offset:4096
    ds_read_b128 a[140:143], v34 offset:2048
    ds_read_b128 a[188:191], v30 offset:5120
    ds_read_b128 a[144:147], v35 offset:0
    ds_read_b128 a[148:151], v35 offset:1024
    ds_read_b128 a[152:155], v35 offset:2048
    ds_read_b128 a[156:159], v36 offset:0
    ds_read_b128 a[160:163], v36 offset:1024
    ds_read_b128 a[164:167], v36 offset:2048
    s_cmp_eq_u32 s50, s64
    s_waitcnt lgkmcnt(15)
    v_mfma_f32_32x32x16_bf16 v[156:171], a[168:171], a[120:123], v[188:203]
    s_cbranch_scc0 L_nm0
    s_nop 8
    v_mfma_f32_32x32x16_bf16 v[156:171], a[168:171], a[120:123], v[192:207]
L_nm0:
    ds_read_b128 a[192:195], v29 offset:6144
    s_add_u32 m0, s47, 18432
    s_nop 0
    buffer_load_dwordx4 v23, s[16:19], s51 offen offset:0 sc1 lds
    s_waitcnt lgkmcnt(15)
    v_mfma_f32_32x32x16_bf16 v[156:171], a[172:175], a[124:127], v[156:171]
    ds_read_b128 a[196:199], v30 offset:7168
    buffer_load_dwordx4 v23, s[16:19], s51 offen offset:1024 sc1 lds
    s_waitcnt lgkmcnt(14)
    v_mfma_f32_32x32x16_bf16 v[156:171], a[176:179], a[128:131], v[156:171]
    ds_read_b128 a[200:203], v29 offset:8192
    buffer_load_dwordx4 v23, s[16:19], s51 offen offset:2048 sc1 lds
    s_add_u32 m0, s47, 21504
    s_waitcnt lgkmcnt(13)
    v_mfma_f32_32x32x16_bf16 v[156:171], a[180:183], a[132:135], v[156:171]
    ds_read_b128 a[204:207], v30 offset:9216
    buffer_load_dwordx4 v24, s[16:19], s51 offen offset:0 sc1 lds
    s_waitcnt lgkmcnt(12)
    v_mfma_f32_32x32x16_bf16 v[156:171], a[184:187], a[136:139], v[156:171]
    ds_read_b128 a[208:211], v29 offset:10240
    buffer_load_dwordx4 v24, s[16:19], s51 offen offset:1024 sc1 lds
    s_waitcnt lgkmcnt(11)
    v_mfma_f32_32x32x16_bf16 v[156:171], a[188:191], a[140:143], v[156:171]
    ds_read_b128 a[212:215], v30 offset:11264
    buffer_load_dwordx4 v24, s[16:19], s51 offen offset:2048 sc1 lds
    s_add_u32 m0, s47, 24576
    s_waitcnt vmcnt(9) lgkmcnt(5)
    v_mfma_f32_32x32x16_bf16 v[156:171], a[192:195], a[144:147], v[156:171]
    ds_read_b128 a[168:171], v29 offset:12288
    buffer_load_dwordx4 v21, s[16:19], s52 offen offset:0 sc1 lds
    s_waitcnt lgkmcnt(5)
    v_mfma_f32_32x32x16_bf16 v[156:171], a[196:199], a[148:151], v[156:171]
    ds_read_b128 a[172:175], v30 offset:13312
    buffer_load_dwordx4 v21, s[16:19], s52 offen offset:1024 sc1 lds
    s_waitcnt lgkmcnt(5)
    v_mfma_f32_32x32x16_bf16 v[156:171], a[200:203], a[152:155], v[156:171]
    ds_read_b128 a[176:179], v29 offset:14336
    buffer_load_dwordx4 v21, s[16:19], s52 offen offset:2048 sc1 lds
    s_add_u32 m0, s47, 27648
    s_waitcnt vmcnt(9) lgkmcnt(5)
    v_mfma_f32_32x32x16_bf16 v[156:171], a[204:207], a[156:159], v[156:171]
    ds_read_b128 a[180:183], v30 offset:15360
    buffer_load_dwordx4 v22, s[16:19], s52 offen offset:0 sc1 lds
    s_waitcnt lgkmcnt(5)
    v_mfma_f32_32x32x16_bf16 v[156:171], a[208:211], a[160:163], v[156:171]
    ds_read_b128 a[184:187], v29 offset:16384
    buffer_load_dwordx4 v22, s[16:19], s52 offen offset:1024 sc1 lds
    s_waitcnt lgkmcnt(5)
    v_mfma_f32_32x32x16_bf16 v[156:171], a[212:215], a[164:167], v[156:171]
    ds_read_b128 a[188:191], v30 offset:17408
    buffer_load_dwordx4 v22, s[16:19], s52 offen offset:2048 sc1 lds
    s_add_u32 m0, s47, 30720
    s_nop 0
    buffer_load_dwordx4 v23, s[16:19], s52 offen offset:0 sc1 lds
    s_nop 6
    v_max3_f32 v219, v156, v157, v158
    v_max3_f32 v219, v219, v159, v160
    v_max3_f32 v219, v219, v161, v162
    v_max3_f32 v219, v219, v163, v164
    v_max3_f32 v219, v219, v165, v166
    v_max3_f32 v219, v219, v167, v168
    v_max3_f32 v219, v219, v169, v170
    v_max_f32 v219, v219, v171
    v_mov_b32 v7, v219
    s_nop 1
    v_permlane32_swap_b32 v219, v7
    v_max_f32 v216, v219, v7
    v_add_f32 v216, 0x40c00000, v216
    buffer_load_dwordx4 v23, s[16:19], s52 offen offset:1024 sc1 lds
    v_pk_add_f32 v[188:189], v[188:189], v[216:217] op_sel_hi:[1,0] neg_lo:[0,1] neg_hi:[0,1]
    v_pk_add_f32 v[190:191], v[190:191], v[216:217] op_sel_hi:[1,0] neg_lo:[0,1] neg_hi:[0,1]
    v_pk_add_f32 v[192:193], v[192:193], v[216:217] op_sel_hi:[1,0] neg_lo:[0,1] neg_hi:[0,1]
    v_pk_add_f32 v[194:195], v[194:195], v[216:217] op_sel_hi:[1,0] neg_lo:[0,1] neg_hi:[0,1]
    v_pk_add_f32 v[196:197], v[196:197], v[216:217] op_sel_hi:[1,0] neg_lo:[0,1] neg_hi:[0,1]
    v_pk_add_f32 v[198:199], v[198:199], v[216:217] op_sel_hi:[1,0] neg_lo:[0,1] neg_hi:[0,1]
    v_pk_add_f32 v[200:201], v[200:201], v[216:217] op_sel_hi:[1,0] neg_lo:[0,1] neg_hi:[0,1]
    v_pk_add_f32 v[202:203], v[202:203], v[216:217] op_sel_hi:[1,0] neg_lo:[0,1] neg_hi:[0,1]
    v_pk_add_f32 v[204:205], v[204:205], v[216:217] op_sel_hi:[1,0] neg_lo:[0,1] neg_hi:[0,1]
    v_pk_add_f32 v[206:207], v[206:207], v[216:217] op_sel_hi:[1,0] neg_lo:[0,1] neg_hi:[0,1]
    v_pk_add_f32 v[156:157], v[156:157], v[216:217] op_sel_hi:[1,0] neg_lo:[0,1] neg_hi:[0,1]
    v_pk_add_f32 v[158:159], v[158:159], v[216:217] op_sel_hi:[1,0] neg_lo:[0,1] neg_hi:[0,1]
    v_pk_add_f32 v[160:161], v[160:161], v[216:217] op_sel_hi:[1,0] neg_lo:[0,1] neg_hi:[0,1]
    v_pk_add_f32 v[162:163], v[162:163], v[216:217] op_sel_hi:[1,0] neg_lo:[0,1] neg_hi:[0,1]
    v_pk_add_f32 v[164:165], v[164:165], v[216:217] op_sel_hi:[1,0] neg_lo:[0,1] neg_hi:[0,1]
    v_pk_add_f32 v[166:167], v[166:167], v[216:217] op_sel_hi:[1,0] neg_lo:[0,1] neg_hi:[0,1]
    v_pk_add_f32 v[168:169], v[168:169], v[216:217] op_sel_hi:[1,0] neg_lo:[0,1] neg_hi:[0,1]
    v_pk_add_f32 v[170:171], v[170:171], v[216:217] op_sel_hi:[1,0] neg_lo:[0,1] neg_hi:[0,1]
    s_cmp_eq_u32 s51, s64
    s_waitcnt vmcnt(8) lgkmcnt(2)
    v_mfma_f32_32x32x16_bf16 v[172:187], a[168:171], a[120:123], v[188:203]
    s_cbranch_scc0 L_nm1
    s_nop 8
    v_mfma_f32_32x32x16_bf16 v[172:187], a[168:171], a[120:123], v[192:207]
L_nm1:
    ds_read_b128 a[192:195], v29 offset:18432
    buffer_load_dwordx4 v23, s[16:19], s52 offen offset:2048 sc1 lds
    v_exp_f32 v156, v156
    v_exp_f32 v157, v157
    v_mfma_f32_32x32x16_bf16 v[172:187], a[172:175], a[124:127], v[172:187]
    ds_read_b128 a[196:199], v30 offset:19456
    v_exp_f32 v158, v158
    v_add_f32 v217, v217, v156
    s_add_u32 m0, s47, 33792
    v_mfma_f32_32x32x16_bf16 v[172:187], a[176:179], a[128:131], v[172:187]
    ds_read_b128 a[200:203], v29 offset:20480
    buffer_load_dwordx4 v24, s[16:19], s52 offen offset:0 sc1 lds
    v_exp_f32 v159, v159
    v_cvt_pk_bf16_f32 v208, v156, v157
    v_mfma_f32_32x32x16_bf16 v[172:187], a[180:183], a[132:135], v[172:187]
    ds_read_b128 a[204:207], v30 offset:21504
    v_exp_f32 v160, v160
    v_exp_f32 v161, v161
    s_waitcnt lgkmcnt(2)
    v_mfma_f32_32x32x16_bf16 v[172:187], a[184:187], a[136:139], v[172:187]
    ds_read_b128 a[208:211], v29 offset:22528
    buffer_load_dwordx4 v24, s[16:19], s52 offen offset:1024 sc1 lds
    v_exp_f32 v162, v162
    v_cvt_pk_bf16_f32 v209, v158, v159
    v_mfma_f32_32x32x16_bf16 v[172:187], a[188:191], a[140:143], v[172:187]
    ds_read_b128 a[212:215], v30 offset:23552
    v_exp_f32 v163, v163
    v_cvt_pk_bf16_f32 v210, v160, v161
    v_add_f32 v218, v218, v157
    v_mfma_f32_32x32x16_bf16 v[172:187], a[192:195], a[144:147], v[172:187]
    ds_read_b64_tr_b16 a[168:169], v31 offset:0
    ds_read_b64_tr_b16 a[170:171], v32 offset:0
    buffer_load_dwordx4 v24, s[16:19], s52 offen offset:2048 sc1 lds
    v_exp_f32 v164, v164
    v_exp_f32 v165, v165
    v_mfma_f32_32x32x16_bf16 v[172:187], a[196:199], a[148:151], v[172:187]
    ds_read_b64_tr_b16 a[172:173], v31 offset:512
    ds_read_b64_tr_b16 a[174:175], v32 offset:512
    v_exp_f32 v166, v166
    v_cvt_pk_bf16_f32 v211, v162, v163
    v_add_f32 v217, v217, v158
    s_waitcnt lgkmcnt(4)
    v_mfma_f32_32x32x16_bf16 v[172:187], a[200:203], a[152:155], v[172:187]
    ds_read_b64_tr_b16 a[176:177], v31 offset:2048
    ds_read_b64_tr_b16 a[178:179], v32 offset:2048
    v_exp_f32 v167, v167
    v_cvt_pk_bf16_f32 v212, v164, v165
    v_mfma_f32_32x32x16_bf16 v[172:187], a[204:207], a[156:159], v[172:187]
    ds_read_b64_tr_b16 a[180:181], v31 offset:2560
    ds_read_b64_tr_b16 a[182:183], v32 offset:2560
    v_exp_f32 v168, v168
    v_exp_f32 v169, v169
    v_mfma_f32_32x32x16_bf16 v[172:187], a[208:211], a[160:163], v[172:187]
    ds_read_b64_tr_b16 a[184:185], v31 offset:4096
    ds_read_b64_tr_b16 a[186:187], v32 offset:4096
    v_exp_f32 v170, v170
    v_cvt_pk_bf16_f32 v213, v166, v167
    v_mfma_f32_32x32x16_bf16 v[172:187], a[212:215], a[164:167], v[172:187]
    ds_read_b64_tr_b16 a[188:189], v31 offset:4608
    ds_read_b64_tr_b16 a[190:191], v32 offset:4608
    v_exp_f32 v171, v171
    v_cvt_pk_bf16_f32 v214, v168, v169
    v_add_f32 v218, v218, v159
    v_cvt_pk_bf16_f32 v215, v170, v171
    s_waitcnt lgkmcnt(4)
    v_mfma_f32_32x32x16_bf16 v[60:75], a[168:171], v[208:211], 0
    ds_read_b64_tr_b16 a[192:193], v31 offset:6144
    ds_read_b64_tr_b16 a[194:195], v32 offset:6144
    s_add_u32 m0, s47, 0
    s_nop 0
    buffer_load_dwordx4 v21, s[16:19], s53 offen offset:0 sc1 lds
    v_add_f32 v217, v217, v160
    v_mfma_f32_32x32x16_bf16 v[60:75], a[172:175], v[212:215], v[60:75]
    ds_read_b64_tr_b16 a[196:197], v31 offset:6656
    ds_read_b64_tr_b16 a[198:199], v32 offset:6656
    v_add_f32 v218, v218, v161
    v_mfma_f32_32x32x16_bf16 v[76:91], a[176:179], v[208:211], 0
    ds_read_b64_tr_b16 a[200:201], v31 offset:8192
    ds_read_b64_tr_b16 a[202:203], v32 offset:8192
    buffer_load_dwordx4 v21, s[16:19], s53 offen offset:1024 sc1 lds
    v_add_f32 v217, v217, v162
    v_max3_f32 v219, v172, v173, v174
    v_mfma_f32_32x32x16_bf16 v[76:91], a[180:183], v[212:215], v[76:91]
    ds_read_b64_tr_b16 a[204:205], v31 offset:8704
    ds_read_b64_tr_b16 a[206:207], v32 offset:8704
    v_add_f32 v218, v218, v163
    v_max3_f32 v219, v219, v175, v176
    s_waitcnt vmcnt(11) lgkmcnt(4)
    v_mfma_f32_32x32x16_bf16 v[92:107], a[184:187], v[208:211], 0
    ds_read_b64_tr_b16 a[208:209], v31 offset:10240
    ds_read_b64_tr_b16 a[210:211], v32 offset:10240
    buffer_load_dwordx4 v21, s[16:19], s53 offen offset:2048 sc1 lds
    v_add_f32 v217, v217, v164
    v_max3_f32 v219, v219, v177, v178
    v_mfma_f32_32x32x16_bf16 v[92:107], a[188:191], v[212:215], v[92:107]
    ds_read_b64_tr_b16 a[212:213], v31 offset:10752
    ds_read_b64_tr_b16 a[214:215], v32 offset:10752
    v_add_f32 v218, v218, v165
    v_max3_f32 v219, v219, v179, v180
    s_add_u32 m0, s47, 3072
    v_mfma_f32_32x32x16_bf16 v[108:123], a[192:195], v[208:211], 0
    ds_read_b128 a[168:171], v29 offset:24576
    buffer_load_dwordx4 v22, s[16:19], s53 offen offset:0 sc1 lds
    v_add_f32 v217, v217, v166
    v_max3_f32 v219, v219, v181, v182
    v_mfma_f32_32x32x16_bf16 v[108:123], a[196:199], v[212:215], v[108:123]
    ds_read_b128 a[172:175], v30 offset:25600
    v_add_f32 v218, v218, v167
    v_max3_f32 v219, v219, v183, v184
    s_waitcnt vmcnt(10) lgkmcnt(2)
    v_mfma_f32_32x32x16_bf16 v[124:139], a[200:203], v[208:211], 0
    ds_read_b128 a[176:179], v29 offset:26624
    buffer_load_dwordx4 v22, s[16:19], s53 offen offset:1024 sc1 lds
    v_add_f32 v217, v217, v168
    v_max3_f32 v219, v219, v185, v186
    v_mfma_f32_32x32x16_bf16 v[124:139], a[204:207], v[212:215], v[124:139]
    ds_read_b128 a[180:183], v30 offset:27648
    v_add_f32 v218, v218, v169
    v_max_f32 v219, v219, v187
    v_mfma_f32_32x32x16_bf16 v[140:155], a[208:211], v[208:211], 0
    ds_read_b128 a[184:187], v29 offset:28672
    buffer_load_dwordx4 v22, s[16:19], s53 offen offset:2048 sc1 lds
    v_add_f32 v217, v217, v170
    v_cmp_lt_f32 vcc, 4.0, v219
    v_mfma_f32_32x32x16_bf16 v[140:155], a[212:215], v[212:215], v[140:155]
    ds_read_b128 a[188:191], v30 offset:29696
    v_add_f32 v218, v218, v171
    s_cmp_eq_u32 s52, s64
    s_cbranch_vccnz L_slow0
L_ok0:
    s_waitcnt vmcnt(6) lgkmcnt(2)
    v_mfma_f32_32x32x16_bf16 v[156:171], a[168:171], a[120:123], v[188:203]
    s_cbranch_scc0 L_nm2
    s_nop 8
    v_mfma_f32_32x32x16_bf16 v[156:171], a[168:171], a[120:123], v[192:207]
L_nm2:
    ds_read_b128 a[192:195], v29 offset:30720
    s_add_u32 m0, s47, 6144
    s_nop 0
    buffer_load_dwordx4 v23, s[16:19], s53 offen offset:0 sc1 lds
    v_exp_f32 v172, v172
    v_exp_f32 v173, v173
    v_mfma_f32_32x32x16_bf16 v[156:171], a[172:175], a[124:127], v[156:171]
    ds_read_b128 a[196:199], v30 offset:31744
    v_exp_f32 v174, v174
    v_add_f32 v217, v217, v172
    v_mfma_f32_32x32x16_bf16 v[156:171], a[176:179], a[128:131], v[156:171]
    ds_read_b128 a[200:203], v29 offset:32768
    buffer_load_dwordx4 v23, s[16:19], s53 offen offset:1024 sc1 lds
    v_exp_f32 v175, v175
    v_cvt_pk_bf16_f32 v208, v172, v173
    v_mfma_f32_32x32x16_bf16 v[156:171], a[180:183], a[132:135], v[156:171]
    ds_read_b128 a[204:207], v30 offset:33792
    v_exp_f32 v176, v176
    v_exp_f32 v177, v177
    s_waitcnt lgkmcnt(2)
    v_mfma_f32_32x32x16_bf16 v[156:171], a[184:187], a[136:139], v[156:171]
    ds_read_b128 a[208:211], v29 offset:34816
    buffer_load_dwordx4 v23, s[16:19], s53 offen offset:2048 sc1 lds
    v_exp_f32 v178, v178
    v_cvt_pk_bf16_f32 v209, v174, v175
    v_mfma_f32_32x32x16_bf16 v[156:171], a[188:191], a[140:143], v[156:171]
    ds_read_b128 a[212:215], v30 offset:35840
    v_exp_f32 v179, v179
    v_cvt_pk_bf16_f32 v210, v176, v177
    v_add_f32 v218, v218, v173
    s_add_u32 m0, s47, 9216
    v_mfma_f32_32x32x16_bf16 v[156:171], a[192:195], a[144:147], v[156:171]
    ds_read_b64_tr_b16 a[168:169], v31 offset:12288
    ds_read_b64_tr_b16 a[170:171], v32 offset:12288
    buffer_load_dwordx4 v24, s[16:19], s53 offen offset:0 sc1 lds
    v_exp_f32 v180, v180
    v_exp_f32 v181, v181
    v_mfma_f32_32x32x16_bf16 v[156:171], a[196:199], a[148:151], v[156:171]
    ds_read_b64_tr_b16 a[172:173], v31 offset:12800
    ds_read_b64_tr_b16 a[174:175], v32 offset:12800
    v_exp_f32 v182, v182
    v_cvt_pk_bf16_f32 v211, v178, v179
    v_add_f32 v217, v217, v174
    s_waitcnt lgkmcnt(4)
    v_mfma_f32_32x32x16_bf16 v[156:171], a[200:203], a[152:155], v[156:171]
    ds_read_b64_tr_b16 a[176:177], v31 offset:14336
    ds_read_b64_tr_b16 a[178:179], v32 offset:14336
    buffer_load_dwordx4 v24, s[16:19], s53 offen offset:1024 sc1 lds
    v_exp_f32 v183, v183
    v_cvt_pk_bf16_f32 v212, v180, v181
    v_mfma_f32_32x32x16_bf16 v[156:171], a[204:207], a[156:159], v[156:171]
    ds_read_b64_tr_b16 a[180:181], v31 offset:14848
    ds_read_b64_tr_b16 a[182:183], v32 offset:14848
    v_exp_f32 v184, v184
    v_exp_f32 v185, v185
    v_mfma_f32_32x32x16_bf16 v[156:171], a[208:211], a[160:163], v[156:171]
    ds_read_b64_tr_b16 a[184:185], v31 offset:16384
    ds_read_b64_tr_b16 a[186:187], v32 offset:16384
    buffer_load_dwordx4 v24, s[16:19], s53 offen offset:2048 sc1 lds
    v_exp_f32 v186, v186
    v_cvt_pk_bf16_f32 v213, v182, v183
    v_mfma_f32_32x32x16_bf16 v[156:171], a[212:215], a[164:167], v[156:171]
    ds_read_b64_tr_b16 a[188:189], v31 offset:16896
    ds_read_b64_tr_b16 a[190:191], v32 offset:16896
    v_exp_f32 v187, v187
    v_cvt_pk_bf16_f32 v214, v184, v185
    v_add_f32 v218, v218, v175
    v_cvt_pk_bf16_f32 v215, v186, v187
    s_waitcnt lgkmcnt(4)
    v_mfma_f32_32x32x16_bf16 v[60:75], a[168:171], v[208:211], v[60:75]
    ds_read_b64_tr_b16 a[192:193], v31 offset:18432
    ds_read_b64_tr_b16 a[194:195], v32 offset:18432
    s_add_u32 m0, s47, 12288
    s_nop 0
    buffer_load_dwordx4 v21, s[16:19], s54 offen offset:0 sc1 lds
    v_add_f32 v217, v217, v176
    v_mfma_f32_32x32x16_bf16 v[60:75], a[172:175], v[212:215], v[60:75]
    ds_read_b64_tr_b16 a[196:197], v31 offset:18944
    ds_read_b64_tr_b16 a[198:199], v32 offset:18944
    v_add_f32 v218, v218, v177
    v_mfma_f32_32x32x16_bf16 v[76:91], a[176:179], v[208:211], v[76:91]
    ds_read_b64_tr_b16 a[200:201], v31 offset:20480
    ds_read_b64_tr_b16 a[202:203], v32 offset:20480
    buffer_load_dwordx4 v21, s[16:19], s54 offen offset:1024 sc1 lds
    v_add_f32 v217, v217, v178
    v_max3_f32 v219, v156, v157, v158
    v_mfma_f32_32x32x16_bf16 v[76:91], a[180:183], v[212:215], v[76:91]
    ds_read_b64_tr_b16 a[204:205], v31 offset:20992
    ds_read_b64_tr_b16 a[206:207], v32 offset:20992
    v_add_f32 v218, v218, v179
    v_max3_f32 v219, v219, v159, v160
    s_waitcnt vmcnt(11) lgkmcnt(4)
    v_mfma_f32_32x32x16_bf16 v[92:107], a[184:187], v[208:211], v[92:107]
    ds_read_b64_tr_b16 a[208:209], v31 offset:22528
    ds_read_b64_tr_b16 a[210:211], v32 offset:22528
    buffer_load_dwordx4 v21, s[16:19], s54 offen offset:2048 sc1 lds
    v_add_f32 v217, v217, v180
    v_max3_f32 v219, v219, v161, v162
    v_mfma_f32_32x32x16_bf16 v[92:107], a[188:191], v[212:215], v[92:107]
    ds_read_b64_tr_b16 a[212:213], v31 offset:23040
    ds_read_b64_tr_b16 a[214:215], v32 offset:23040
    v_add_f32 v218, v218, v181
    v_max3_f32 v219, v219, v163, v164
    s_add_u32 m0, s47, 15360
    v_mfma_f32_32x32x16_bf16 v[108:123], a[192:195], v[208:211], v[108:123]
    ds_read_b128 a[168:171], v29 offset:0
    buffer_load_dwordx4 v22, s[16:19], s54 offen offset:0 sc1 lds
    v_add_f32 v217, v217, v182
    v_max3_f32 v219, v219, v165, v166
    v_mfma_f32_32x32x16_bf16 v[108:123], a[196:199], v[212:215], v[108:123]
    ds_read_b128 a[172:175], v30 offset:1024
    v_add_f32 v218, v218, v183
    v_max3_f32 v219, v219, v167, v168
    s_waitcnt vmcnt(10) lgkmcnt(2)
    v_mfma_f32_32x32x16_bf16 v[124:139], a[200:203], v[208:211], v[124:139]
    ds_read_b128 a[176:179], v29 offset:2048
    buffer_load_dwordx4 v22, s[16:19], s54 offen offset:1024 sc1 lds
    v_add_f32 v217, v217, v184
    v_max3_f32 v219, v219, v169, v170
    v_mfma_f32_32x32x16_bf16 v[124:139], a[204:207], v[212:215], v[124:139]
    ds_read_b128 a[180:183], v30 offset:3072
    v_add_f32 v218, v218, v185
    v_max_f32 v219, v219, v171
    v_mfma_f32_32x32x16_bf16 v[140:155], a[208:211], v[208:211], v[140:155]
    ds_read_b128 a[184:187], v29 offset:4096
    buffer_load_dwordx4 v22, s[16:19], s54 offen offset:2048 sc1 lds
    v_add_f32 v217, v217, v186
    v_cmp_lt_f32 vcc, 4.0, v219
    v_mfma_f32_32x32x16_bf16 v[140:155], a[212:215], v[212:215], v[140:155]
    ds_read_b128 a[188:191], v30 offset:5120
    v_add_f32 v218, v218, v187
    s_cmp_eq_u32 s53, s64
    s_cbranch_vccnz L_slow1
L_ok1:
    v_cmp_ne_u32 vcc, 1, v6
    s_cbranch_vccnz L_waitB
L_haveB:
    s_waitcnt vmcnt(6) lgkmcnt(2)
    v_mfma_f32_32x32x16_bf16 v[172:187], a[168:171], a[120:123], v[188:203]
    s_cbranch_scc0 L_nm3
    s_nop 8
    v_mfma_f32_32x32x16_bf16 v[172:187], a[168:171], a[120:123], v[192:207]
L_nm3:
    ds_read_b128 a[192:195], v29 offset:6144
    s_add_u32 m0, s47, 18432
    s_nop 0
    buffer_load_dwordx4 v23, s[16:19], s54 offen offset:0 sc1 lds
    v_exp_f32 v156, v156
    v_exp_f32 v157, v157
    v_mfma_f32_32x32x16_bf16 v[172:187], a[172:175], a[124:127], v[172:187]
    ds_read_b128 a[196:199], v30 offset:7168
    v_exp_f32 v158, v158
    v_add_f32 v217, v217, v156
    v_mfma_f32_32x32x16_bf16 v[172:187], a[176:179], a[128:131], v[172:187]
    ds_read_b128 a[200:203], v29 offset:8192
    buffer_load_dwordx4 v23, s[16:19], s54 offen offset:1024 sc1 lds
    v_exp_f32 v159, v159
    v_cvt_pk_bf16_f32 v208, v156, v157
    v_mfma_f32_32x32x16_bf16 v[172:187], a[180:183], a[132:135], v[172:187]
    ds_read_b128 a[204:207], v30 offset:9216
    v_exp_f32 v160, v160
    v_exp_f32 v161, v161
    s_waitcnt lgkmcnt(2)
    v_mfma_f32_32x32x16_bf16 v[172:187], a[184:187], a[136:139], v[172:187]
    ds_read_b128 a[208:211], v29 offset:10240
    buffer_load_dwordx4 v23, s[16:19], s54 offen offset:2048 sc1 lds
    v_exp_f32 v162, v162
    v_cvt_pk_bf16_f32 v209, v158, v159
    v_mfma_f32_32x32x16_bf16 v[172:187], a[188:191], a[140:143], v[172:187]
    ds_read_b128 a[212:215], v30 offset:11264
    v_exp_f32 v163, v163
    v_cvt_pk_bf16_f32 v210, v160, v161
    v_add_f32 v218, v218, v157
    s_add_u32 m0, s47, 21504
    v_mfma_f32_32x32x16_bf16 v[172:187], a[192:195], a[144:147], v[172:187]
    ds_read_b64_tr_b16 a[168:169], v31 offset:24576
    ds_read_b64_tr_b16 a[170:171], v32 offset:24576
    buffer_load_dwordx4 v24, s[16:19], s54 offen offset:0 sc1 lds
    v_exp_f32 v164, v164
    v_exp_f32 v165, v165
    v_mfma_f32_32x32x16_bf16 v[172:187], a[196:199], a[148:151], v[172:187]
    ds_read_b64_tr_b16 a[172:173], v31 offset:25088
    ds_read_b64_tr_b16 a[174:175], v32 offset:25088
    v_exp_f32 v166, v166
    v_cvt_pk_bf16_f32 v211, v162, v163
    v_add_f32 v217, v217, v158
    s_waitcnt lgkmcnt(4)
    v_mfma_f32_32x32x16_bf16 v[172:187], a[200:203], a[152:155], v[172:187]
    ds_read_b64_tr_b16 a[176:177], v31 offset:26624
    ds_read_b64_tr_b16 a[178:179], v32 offset:26624
    buffer_load_dwordx4 v24, s[16:19], s54 offen offset:1024 sc1 lds
    v_exp_f32 v167, v167
    v_cvt_pk_bf16_f32 v212, v164, v165
    v_mfma_f32_32x32x16_bf16 v[172:187], a[204:207], a[156:159], v[172:187]
    ds_read_b64_tr_b16 a[180:181], v31 offset:27136
    ds_read_b64_tr_b16 a[182:183], v32 offset:27136
    v_exp_f32 v168, v168
    v_exp_f32 v169, v169
    v_mfma_f32_32x32x16_bf16 v[172:187], a[208:211], a[160:163], v[172:187]
    ds_read_b64_tr_b16 a[184:185], v31 offset:28672
    ds_read_b64_tr_b16 a[186:187], v32 offset:28672
    buffer_load_dwordx4 v24, s[16:19], s54 offen offset:2048 sc1 lds
    v_exp_f32 v170, v170
    v_cvt_pk_bf16_f32 v213, v166, v167
    v_mfma_f32_32x32x16_bf16 v[172:187], a[212:215], a[164:167], v[172:187]
    ds_read_b64_tr_b16 a[188:189], v31 offset:29184
    ds_read_b64_tr_b16 a[190:191], v32 offset:29184
    v_exp_f32 v171, v171
    v_cvt_pk_bf16_f32 v214, v168, v169
    v_add_f32 v218, v218, v159
    v_cvt_pk_bf16_f32 v215, v170, v171
    s_waitcnt lgkmcnt(4)
    v_mfma_f32_32x32x16_bf16 v[60:75], a[168:171], v[208:211], v[60:75]
    ds_read_b64_tr_b16 a[192:193], v31 offset:30720
    ds_read_b64_tr_b16 a[194:195], v32 offset:30720
    s_add_u32 m0, s47, 24576
    s_nop 0
    buffer_load_dwordx4 v25, s[16:19], s55 offen offset:0 sc1 lds
    v_add_f32 v217, v217, v160
    v_mfma_f32_32x32x16_bf16 v[60:75], a[172:175], v[212:215], v[60:75]
    ds_read_b64_tr_b16 a[196:197], v31 offset:31232
    ds_read_b64_tr_b16 a[198:199], v32 offset:31232
    v_add_f32 v218, v218, v161
    v_mfma_f32_32x32x16_bf16 v[76:91], a[176:179], v[208:211], v[76:91]
    ds_read_b64_tr_b16 a[200:201], v31 offset:32768
    ds_read_b64_tr_b16 a[202:203], v32 offset:32768
    buffer_load_dwordx4 v25, s[16:19], s55 offen offset:1024 sc1 lds
    v_add_f32 v217, v217, v162
    v_max3_f32 v219, v172, v173, v174
    v_mfma_f32_32x32x16_bf16 v[76:91], a[180:183], v[212:215], v[76:91]
    ds_read_b64_tr_b16 a[204:205], v31 offset:33280
    ds_read_b64_tr_b16 a[206:207], v32 offset:33280
    v_add_f32 v218, v218, v163
    v_max3_f32 v219, v219, v175, v176
    s_waitcnt vmcnt(11) lgkmcnt(4)
    v_mfma_f32_32x32x16_bf16 v[92:107], a[184:187], v[208:211], v[92:107]
    ds_read_b64_tr_b16 a[208:209], v31 offset:34816
    ds_read_b64_tr_b16 a[210:211], v32 offset:34816
    buffer_load_dwordx4 v25, s[16:19], s55 offen offset:2048 sc1 lds
    v_add_f32 v217, v217, v164
    v_max3_f32 v219, v219, v177, v178
    v_mfma_f32_32x32x16_bf16 v[92:107], a[188:191], v[212:215], v[92:107]
    ds_read_b64_tr_b16 a[212:213], v31 offset:35328
    ds_read_b64_tr_b16 a[214:215], v32 offset:35328
    v_add_f32 v218, v218, v165
    v_max3_f32 v219, v219, v179, v180
    s_add_u32 m0, s47, 27648
    v_mfma_f32_32x32x16_bf16 v[108:123], a[192:195], v[208:211], v[108:123]
    ds_read_b128 a[168:171], v29 offset:12288
    buffer_load_dwordx4 v26, s[16:19], s55 offen offset:0 sc1 lds
    v_add_f32 v217, v217, v166
    v_max3_f32 v219, v219, v181, v182
    v_mfma_f32_32x32x16_bf16 v[108:123], a[196:199], v[212:215], v[108:123]
    ds_read_b128 a[172:175], v30 offset:13312
    v_add_f32 v218, v218, v167
    v_max3_f32 v219, v219, v183, v184
    s_waitcnt vmcnt(10) lgkmcnt(2)
    v_mfma_f32_32x32x16_bf16 v[124:139], a[200:203], v[208:211], v[124:139]
    ds_read_b128 a[176:179], v29 offset:14336
    buffer_load_dwordx4 v26, s[16:19], s55 offen offset:1024 sc1 lds
    v_add_f32 v217, v217, v168
    v_max3_f32 v219, v219, v185, v186
    v_mfma_f32_32x32x16_bf16 v[124:139], a[204:207], v[212:215], v[124:139]
    ds_read_b128 a[180:183], v30 offset:15360
    v_add_f32 v218, v218, v169
    v_max_f32 v219, v219, v187
    v_mfma_f32_32x32x16_bf16 v[140:155], a[208:211], v[208:211], v[140:155]
    ds_read_b128 a[184:187], v29 offset:16384
    buffer_load_dwordx4 v26, s[16:19], s55 offen offset:2048 sc1 lds
    v_add_f32 v217, v217, v170
    v_cmp_lt_f32 vcc, 4.0, v219
    v_mfma_f32_32x32x16_bf16 v[140:155], a[212:215], v[212:215], v[140:155]
    ds_read_b128 a[188:191], v30 offset:17408
    v_add_f32 v218, v218, v171
    s_cmp_eq_u32 s54, s64
    s_cbranch_vccnz L_slow2
L_ok2:
    s_waitcnt vmcnt(6) lgkmcnt(2)
    v_mfma_f32_32x32x16_bf16 v[156:171], a[168:171], a[120:123], v[188:203]
    s_cbranch_scc0 L_nm4
    s_nop 8
    v_mfma_f32_32x32x16_bf16 v[156:171], a[168:171], a[120:123], v[192:207]
L_nm4:
    ds_read_b128 a[192:195], v29 offset:18432
    s_add_u32 m0, s47, 30720
    s_nop 0
    buffer_load_dwordx4 v27, s[16:19], s55 offen offset:0 sc1 lds
    v_exp_f32 v172, v172
    v_exp_f32 v173, v173
    v_mfma_f32_32x32x16_bf16 v[156:171], a[172:175], a[124:127], v[156:171]
    ds_read_b128 a[196:199], v30 offset:19456
    v_exp_f32 v174, v174
    v_add_f32 v217, v217, v172
    v_mfma_f32_32x32x16_bf16 v[156:171], a[176:179], a[128:131], v[156:171]
    ds_read_b128 a[200:203], v29 offset:20480
    buffer_load_dwordx4 v27, s[16:19], s55 offen offset:1024 sc1 lds
    v_exp_f32 v175, v175
    v_cvt_pk_bf16_f32 v208, v172, v173
    v_mfma_f32_32x32x16_bf16 v[156:171], a[180:183], a[132:135], v[156:171]
    ds_read_b128 a[204:207], v30 offset:21504
    v_exp_f32 v176, v176
    v_exp_f32 v177, v177
    s_waitcnt lgkmcnt(2)
    v_mfma_f32_32x32x16_bf16 v[156:171], a[184:187], a[136:139], v[156:171]
    ds_read_b128 a[208:211], v29 offset:22528
    buffer_load_dwordx4 v27, s[16:19], s55 offen offset:2048 sc1 lds
    v_exp_f32 v178, v178
    v_cvt_pk_bf16_f32 v209, v174, v175
    v_mfma_f32_32x32x16_bf16 v[156:171], a[188:191], a[140:143], v[156:171]
    ds_read_b128 a[212:215], v30 offset:23552
    v_exp_f32 v179, v179
    v_cvt_pk_bf16_f32 v210, v176, v177
    v_add_f32 v218, v218, v173
    s_add_u32 m0, s47, 33792
    v_mfma_f32_32x32x16_bf16 v[156:171], a[192:195], a[144:147], v[156:171]
    ds_read_b64_tr_b16 a[168:169], v31 offset:0
    ds_read_b64_tr_b16 a[170:171], v32 offset:0
    buffer_load_dwordx4 v28, s[16:19], s55 offen offset:0 sc1 lds
    v_exp_f32 v180, v180
    v_exp_f32 v181, v181
    v_mfma_f32_32x32x16_bf16 v[156:171], a[196:199], a[148:151], v[156:171]
    ds_read_b64_tr_b16 a[172:173], v31 offset:512
    ds_read_b64_tr_b16 a[174:175], v32 offset:512
    v_exp_f32 v182, v182
    v_cvt_pk_bf16_f32 v211, v178, v179
    v_add_f32 v217, v217, v174
    s_waitcnt lgkmcnt(4)
    v_mfma_f32_32x32x16_bf16 v[156:171], a[200:203], a[152:155], v[156:171]
    ds_read_b64_tr_b16 a[176:177], v31 offset:2048
    ds_read_b64_tr_b16 a[178:179], v32 offset:2048
    buffer_load_dwordx4 v28, s[16:19], s55 offen offset:1024 sc1 lds
    v_exp_f32 v183, v183
    v_cvt_pk_bf16_f32 v212, v180, v181
    v_mfma_f32_32x32x16_bf16 v[156:171], a[204:207], a[156:159], v[156:171]
    ds_read_b64_tr_b16 a[180:181], v31 offset:2560
    ds_read_b64_tr_b16 a[182:183], v32 offset:2560
    v_exp_f32 v184, v184
    v_exp_f32 v185, v185
    v_mfma_f32_32x32x16_bf16 v[156:171], a[208:211], a[160:163], v[156:171]
    ds_read_b64_tr_b16 a[184:185], v31 offset:4096
    ds_read_b64_tr_b16 a[186:187], v32 offset:4096
    buffer_load_dwordx4 v28, s[16:19], s55 offen offset:2048 sc1 lds
    v_exp_f32 v186, v186
    v_cvt_pk_bf16_f32 v213, v182, v183
    v_mfma_f32_32x32x16_bf16 v[156:171], a[212:215], a[164:167], v[156:171]
    ds_read_b64_tr_b16 a[188:189], v31 offset:4608
    ds_read_b64_tr_b16 a[190:191], v32 offset:4608
    v_exp_f32 v187, v187
    v_cvt_pk_bf16_f32 v214, v184, v185
    v_add_f32 v218, v218, v175
    v_cvt_pk_bf16_f32 v215, v186, v187
    s_waitcnt lgkmcnt(4)
    v_mfma_f32_32x32x16_bf16 v[60:75], a[168:171], v[208:211], v[60:75]
    ds_read_b64_tr_b16 a[192:193], v31 offset:6144
    ds_read_b64_tr_b16 a[194:195], v32 offset:6144
    s_add_u32 s46, s69, 2236416
    buffer_load_dwordx4 a[48:51], v1, s[16:19], s46 offen offset:0 sc1
    v_add_f32 v217, v217, v176
    v_mfma_f32_32x32x16_bf16 v[60:75], a[172:175], v[212:215], v[60:75]
    ds_read_b64_tr_b16 a[196:197], v31 offset:6656
    ds_read_b64_tr_b16 a[198:199], v32 offset:6656
    v_add_f32 v218, v218, v177
    v_mfma_f32_32x32x16_bf16 v[76:91], a[176:179], v[208:211], v[76:91]
    ds_read_b64_tr_b16 a[200:201], v31 offset:8192
    ds_read_b64_tr_b16 a[202:203], v32 offset:8192
    buffer_load_dwordx4 a[52:55], v1, s[16:19], s46 offen offset:1024 sc1
    v_add_f32 v217, v217, v178
    v_max3_f32 v219, v156, v157, v158
    v_mfma_f32_32x32x16_bf16 v[76:91], a[180:183], v[212:215], v[76:91]
    ds_read_b64_tr_b16 a[204:205], v31 offset:8704
    ds_read_b64_tr_b16 a[206:207], v32 offset:8704
    v_add_f32 v218, v218, v179
    v_max3_f32 v219, v219, v159, v160
    s_waitcnt vmcnt(11) lgkmcnt(4)
    v_mfma_f32_32x32x16_bf16 v[92:107], a[184:187], v[208:211], v[92:107]
    ds_read_b64_tr_b16 a[208:209], v31 offset:10240
    ds_read_b64_tr_b16 a[210:211], v32 offset:10240
    buffer_load_dwordx4 a[56:59], v1, s[16:19], s46 offen offset:2048 sc1
    v_add_f32 v217, v217, v180
    v_max3_f32 v219, v219, v161, v162
    v_mfma_f32_32x32x16_bf16 v[92:107], a[188:191], v[212:215], v[92:107]
    ds_read_b64_tr_b16 a[212:213], v31 offset:10752
    ds_read_b64_tr_b16 a[214:215], v32 offset:10752
    v_add_f32 v218, v218, v181
    v_max3_f32 v219, v219, v163, v164
    v_mfma_f32_32x32x16_bf16 v[108:123], a[192:195], v[208:211], v[108:123]
    ds_read_b128 a[168:171], v29 offset:24576
    buffer_load_dwordx4 a[60:63], v1, s[16:19], s46 offen offset:3072 sc1
    v_add_f32 v217, v217, v182
    v_max3_f32 v219, v219, v165, v166
    v_mfma_f32_32x32x16_bf16 v[108:123], a[196:199], v[212:215], v[108:123]
    ds_read_b128 a[172:175], v30 offset:25600
    v_add_f32 v218, v218, v183
    v_max3_f32 v219, v219, v167, v168
    s_add_u32 s46, s69, 2240512
    s_waitcnt vmcnt(10) lgkmcnt(2)
    v_mfma_f32_32x32x16_bf16 v[124:139], a[200:203], v[208:211], v[124:139]
    ds_read_b128 a[176:179], v29 offset:26624
    buffer_load_dwordx4 a[64:67], v1, s[16:19], s46 offen offset:0 sc1
    v_add_f32 v217, v217, v184
    v_max3_f32 v219, v219, v169, v170
    v_mfma_f32_32x32x16_bf16 v[124:139], a[204:207], v[212:215], v[124:139]
    ds_read_b128 a[180:183], v30 offset:27648
    v_add_f32 v218, v218, v185
    v_max_f32 v219, v219, v171
    v_mfma_f32_32x32x16_bf16 v[140:155], a[208:211], v[208:211], v[140:155]
    ds_read_b128 a[184:187], v29 offset:28672
    buffer_load_dwordx4 a[68:71], v1, s[16:19], s46 offen offset:1024 sc1
    v_add_f32 v217, v217, v186
    v_cmp_lt_f32 vcc, 4.0, v219
    v_mfma_f32_32x32x16_bf16 v[140:155], a[212:215], v[212:215], v[140:155]
    ds_read_b128 a[188:191], v30 offset:29696
    v_add_f32 v218, v218, v187
    s_cbranch_vccnz L_slow3
L_ok3:
    s_cmp_lg_u32 s3, 3
    s_cbranch_scc1 L_w3a
    v_mov_b32 v188, 0xff800000
    v_mov_b32 v189, 0xff800000
    v_mov_b32 v190, 0xff800000
    v_mov_b32 v191, 0xff800000
    v_mov_b32 v192, 0xff800000
    v_mov_b32 v193, 0xff800000
    v_mov_b32 v194, 0xff800000
    v_mov_b32 v195, 0xff800000
    v_mov_b32 v196, 0xff800000
    v_mov_b32 v197, 0xff800000
    v_mov_b32 v198, 0xff800000
    v_mov_b32 v199, 0xff800000
    v_mov_b32 v200, 0xff800000
    v_mov_b32 v201, 0xff800000
    v_mov_b32 v202, 0xff800000
    v_mov_b32 v203, 0xff800000
    v_mov_b32 v204, 0xff800000
    v_mov_b32 v205, 0xff800000
    v_mov_b32 v206, 0xff800000
    v_mov_b32 v207, 0xff800000
L_w3a:
    s_cmp_eq_u32 s55, s64
    s_waitcnt vmcnt(6) lgkmcnt(2)
    v_mfma_f32_32x32x16_bf16 v[172:187], a[168:171], a[120:123], v[188:203]
    s_cbranch_scc0 L_nm5
    s_nop 8
    v_mfma_f32_32x32x16_bf16 v[172:187], a[168:171], a[120:123], v[192:207]
L_nm5:
    ds_read_b128 a[192:195], v29 offset:30720
    buffer_load_dwordx4 a[72:75], v1, s[16:19], s46 offen offset:2048 sc1
    v_exp_f32 v156, v156
    v_exp_f32 v157, v157
    v_mfma_f32_32x32x16_bf16 v[172:187], a[172:175], a[124:127], v[172:187]
    ds_read_b128 a[196:199], v30 offset:31744
    v_exp_f32 v158, v158
    v_add_f32 v217, v217, v156
    v_mfma_f32_32x32x16_bf16 v[172:187], a[176:179], a[128:131], v[172:187]
    ds_read_b128 a[200:203], v29 offset:32768
    buffer_load_dwordx4 a[76:79], v1, s[16:19], s46 offen offset:3072 sc1
    v_exp_f32 v159, v159
    v_cvt_pk_bf16_f32 v208, v156, v157
    v_mfma_f32_32x32x16_bf16 v[172:187], a[180:183], a[132:135], v[172:187]
    ds_read_b128 a[204:207], v30 offset:33792
    v_exp_f32 v160, v160
    v_exp_f32 v161, v161
    s_add_u32 s46, s69, 2244608
    s_waitcnt lgkmcnt(2)
    v_mfma_f32_32x32x16_bf16 v[172:187], a[184:187], a[136:139], v[172:187]
    ds_read_b128 a[208:211], v29 offset:34816
    buffer_load_dwordx4 a[80:83], v1, s[16:19], s46 offen offset:0 sc1
    v_exp_f32 v162, v162
    v_cvt_pk_bf16_f32 v209, v158, v159
    v_mfma_f32_32x32x16_bf16 v[172:187], a[188:191], a[140:143], v[172:187]
    ds_read_b128 a[212:215], v30 offset:35840
    v_exp_f32 v163, v163
    v_cvt_pk_bf16_f32 v210, v160, v161
    v_add_f32 v218, v218, v157
    v_mfma_f32_32x32x16_bf16 v[172:187], a[192:195], a[144:147], v[172:187]
    ds_read_b64_tr_b16 a[168:169], v31 offset:12288
    ds_read_b64_tr_b16 a[170:171], v32 offset:12288
    buffer_load_dwordx4 a[84:87], v1, s[16:19], s46 offen offset:1024 sc1
    v_exp_f32 v164, v164
    v_exp_f32 v165, v165
    v_mfma_f32_32x32x16_bf16 v[172:187], a[196:199], a[148:151], v[172:187]
    ds_read_b64_tr_b16 a[172:173], v31 offset:12800
    ds_read_b64_tr_b16 a[174:175], v32 offset:12800
    v_exp_f32 v166, v166
    v_cvt_pk_bf16_f32 v211, v162, v163
    v_add_f32 v217, v217, v158
    s_waitcnt lgkmcnt(4)
    v_mfma_f32_32x32x16_bf16 v[172:187], a[200:203], a[152:155], v[172:187]
    ds_read_b64_tr_b16 a[176:177], v31 offset:14336
    ds_read_b64_tr_b16 a[178:179], v32 offset:14336
    buffer_load_dwordx4 a[88:91], v1, s[16:19], s46 offen offset:2048 sc1
    v_exp_f32 v167, v167
    v_cvt_pk_bf16_f32 v212, v164, v165
    v_mfma_f32_32x32x16_bf16 v[172:187], a[204:207], a[156:159], v[172:187]
    ds_read_b64_tr_b16 a[180:181], v31 offset:14848
    ds_read_b64_tr_b16 a[182:183], v32 offset:14848
    v_exp_f32 v168, v168
    v_exp_f32 v169, v169
    v_mfma_f32_32x32x16_bf16 v[172:187], a[208:211], a[160:163], v[172:187]
    ds_read_b64_tr_b16 a[184:185], v31 offset:16384
    ds_read_b64_tr_b16 a[186:187], v32 offset:16384
    buffer_load_dwordx4 a[92:95], v1, s[16:19], s46 offen offset:3072 sc1
    v_exp_f32 v170, v170
    v_cvt_pk_bf16_f32 v213, v166, v167
    v_mfma_f32_32x32x16_bf16 v[172:187], a[212:215], a[164:167], v[172:187]
    ds_read_b64_tr_b16 a[188:189], v31 offset:16896
    ds_read_b64_tr_b16 a[190:191], v32 offset:16896
    v_exp_f32 v171, v171
    v_cvt_pk_bf16_f32 v214, v168, v169
    v_add_f32 v218, v218, v159
    v_cvt_pk_bf16_f32 v215, v170, v171
    s_waitcnt lgkmcnt(4)
    v_mfma_f32_32x32x16_bf16 v[60:75], a[168:171], v[208:211], v[60:75]
    ds_read_b64_tr_b16 a[192:193], v31 offset:18432
    ds_read_b64_tr_b16 a[194:195], v32 offset:18432
    s_add_u32 s46, s69, 2248704
    buffer_load_dwordx4 a[96:99], v1, s[16:19], s46 offen offset:0 sc1
    v_add_f32 v217, v217, v160
    v_add_f32 v218, v218, v161
    v_add_f32 v217, v217, v162
    v_add_f32 v218, v218, v163
    v_mfma_f32_32x32x16_bf16 v[60:75], a[172:175], v[212:215], v[60:75]
    ds_read_b64_tr_b16 a[196:197], v31 offset:18944
    ds_read_b64_tr_b16 a[198:199], v32 offset:18944
    v_add_f32 v217, v217, v164
    v_add_f32 v218, v218, v165
    v_add_f32 v217, v217, v166
    v_add_f32 v218, v218, v167
    v_mfma_f32_32x32x16_bf16 v[76:91], a[176:179], v[208:211], v[76:91]
    ds_read_b64_tr_b16 a[200:201], v31 offset:20480
    ds_read_b64_tr_b16 a[202:203], v32 offset:20480
    v_add_f32 v217, v217, v168
    v_add_f32 v218, v218, v169
    v_add_f32 v217, v217, v170
    v_add_f32 v218, v218, v171
    v_max3_f32 v219, v172, v173, v174
    v_max3_f32 v219, v219, v175, v176
    v_max3_f32 v219, v219, v177, v178
    v_mfma_f32_32x32x16_bf16 v[76:91], a[180:183], v[212:215], v[76:91]
    ds_read_b64_tr_b16 a[204:205], v31 offset:20992
    ds_read_b64_tr_b16 a[206:207], v32 offset:20992
    v_max3_f32 v219, v219, v179, v180
    v_max3_f32 v219, v219, v181, v182
    v_max3_f32 v219, v219, v183, v184
    s_waitcnt lgkmcnt(4)
    v_mfma_f32_32x32x16_bf16 v[92:107], a[184:187], v[208:211], v[92:107]
    ds_read_b64_tr_b16 a[208:209], v31 offset:22528
    ds_read_b64_tr_b16 a[210:211], v32 offset:22528
    buffer_load_dwordx4 a[100:103], v1, s[16:19], s46 offen offset:1024 sc1
    v_max3_f32 v219, v219, v185, v186
    v_max_f32 v219, v219, v187
    v_cmp_lt_f32 vcc, 4.0, v219
    v_exp_f32 v156, v172
    v_exp_f32 v157, v173
    v_mfma_f32_32x32x16_bf16 v[92:107], a[188:191], v[212:215], v[92:107]
    ds_read_b64_tr_b16 a[212:213], v31 offset:23040
    ds_read_b64_tr_b16 a[214:215], v32 offset:23040
    v_exp_f32 v158, v174
    v_exp_f32 v159, v175
    v_cvt_pk_bf16_f32 v188, v156, v157
    v_mfma_f32_32x32x16_bf16 v[108:123], a[192:195], v[208:211], v[108:123]
    ds_read_b64_tr_b16 a[168:169], v31 offset:34816
    ds_read_b64_tr_b16 a[170:171], v32 offset:34816
    v_exp_f32 v160, v176
    v_exp_f32 v161, v177
    v_cvt_pk_bf16_f32 v189, v158, v159
    v_mfma_f32_32x32x16_bf16 v[108:123], a[196:199], v[212:215], v[108:123]
    ds_read_b64_tr_b16 a[172:173], v31 offset:35328
    ds_read_b64_tr_b16 a[174:175], v32 offset:35328
    v_exp_f32 v162, v178
    v_exp_f32 v163, v179
    v_cvt_pk_bf16_f32 v190, v160, v161
    s_waitcnt lgkmcnt(4)
    v_mfma_f32_32x32x16_bf16 v[124:139], a[200:203], v[208:211], v[124:139]
    ds_read_b64_tr_b16 a[176:177], v31 offset:32768
    ds_read_b64_tr_b16 a[178:179], v32 offset:32768
    buffer_load_dwordx4 a[104:107], v1, s[16:19], s46 offen offset:2048 sc1
    v_exp_f32 v164, v180
    v_exp_f32 v165, v181
    v_cvt_pk_bf16_f32 v191, v162, v163
    v_mfma_f32_32x32x16_bf16 v[124:139], a[204:207], v[212:215], v[124:139]
    ds_read_b64_tr_b16 a[180:181], v31 offset:33280
    ds_read_b64_tr_b16 a[182:183], v32 offset:33280
    v_exp_f32 v166, v182
    v_exp_f32 v167, v183
    v_cvt_pk_bf16_f32 v192, v164, v165
    v_mfma_f32_32x32x16_bf16 v[140:155], a[208:211], v[208:211], v[140:155]
    ds_read_b64_tr_b16 a[184:185], v31 offset:30720
    ds_read_b64_tr_b16 a[186:187], v32 offset:30720
    v_exp_f32 v168, v184
    v_exp_f32 v169, v185
    v_cvt_pk_bf16_f32 v193, v166, v167
    v_mfma_f32_32x32x16_bf16 v[140:155], a[212:215], v[212:215], v[140:155]
    ds_read_b64_tr_b16 a[188:189], v31 offset:31232
    ds_read_b64_tr_b16 a[190:191], v32 offset:31232
    v_exp_f32 v170, v186
    v_exp_f32 v171, v187
    v_cvt_pk_bf16_f32 v194, v168, v169
    v_cvt_pk_bf16_f32 v195, v170, v171
    s_cbranch_vccnz L_slow4
L_ok4:
    s_waitcnt lgkmcnt(4)
    v_mfma_f32_32x32x16_bf16 v[140:155], a[168:171], v[188:191], v[140:155]
    ds_read_b64_tr_b16 a[192:193], v31 offset:28672
    ds_read_b64_tr_b16 a[194:195], v32 offset:28672
    buffer_load_dwordx4 a[108:111], v1, s[16:19], s46 offen offset:3072 sc1
    v_add_f32 v217, v217, v156
    v_add_f32 v218, v218, v157
    v_add_f32 v217, v217, v158
    v_add_f32 v218, v218, v159
    v_add_f32 v217, v217, v160
    v_mfma_f32_32x32x16_bf16 v[140:155], a[172:175], v[192:195], v[140:155]
    ds_read_b64_tr_b16 a[196:197], v31 offset:29184
    ds_read_b64_tr_b16 a[198:199], v32 offset:29184
    v_add_f32 v218, v218, v161
    v_add_f32 v217, v217, v162
    v_add_f32 v218, v218, v163
    v_add_f32 v217, v217, v164
    v_add_f32 v218, v218, v165
    s_add_u32 s46, s69, 2252800
    v_mfma_f32_32x32x16_bf16 v[124:139], a[176:179], v[188:191], v[124:139]
    ds_read_b64_tr_b16 a[200:201], v31 offset:26624
    ds_read_b64_tr_b16 a[202:203], v32 offset:26624
    buffer_load_dwordx4 a[112:115], v1, s[16:19], s46 offen offset:0 sc1
    v_add_f32 v217, v217, v166
    v_add_f32 v218, v218, v167
    v_add_f32 v217, v217, v168
    v_add_f32 v218, v218, v169
    v_add_f32 v217, v217, v170
    v_add_f32 v218, v218, v171
    v_mfma_f32_32x32x16_bf16 v[124:139], a[180:183], v[192:195], v[124:139]
    ds_read_b64_tr_b16 a[204:205], v31 offset:27136
    ds_read_b64_tr_b16 a[206:207], v32 offset:27136
    v_add_f32 v217, v217, v218
    v_mov_b32 v7, v217
    v_mov_b32 v196, v216
    v_cvt_pk_f16_f32 v172, v148, v149
    v_cvt_pk_f16_f32 v173, v150, v151
    v_cvt_pk_f16_f32 v174, v152, v153
    v_cvt_pk_f16_f32 v175, v154, v155
    s_waitcnt lgkmcnt(4)
    v_mfma_f32_32x32x16_bf16 v[108:123], a[184:187], v[188:191], v[108:123]
    ds_read_b64_tr_b16 a[208:209], v31 offset:24576
    ds_read_b64_tr_b16 a[210:211], v32 offset:24576
    buffer_load_dwordx4 a[116:119], v1, s[16:19], s46 offen offset:1024 sc1
    ds_write_b128 v44, v[172:175] offset:8192
    v_permlane32_swap_b32 v217, v7
    v_add_f32 v197, v217, v7
    v_cvt_pk_f16_f32 v176, v140, v141
    v_cvt_pk_f16_f32 v177, v142, v143
    v_cvt_pk_f16_f32 v178, v144, v145
    v_cvt_pk_f16_f32 v179, v146, v147
    v_mfma_f32_32x32x16_bf16 v[108:123], a[188:191], v[192:195], v[108:123]
    ds_read_b64_tr_b16 a[212:213], v31 offset:25088
    ds_read_b64_tr_b16 a[214:215], v32 offset:25088
    ds_write_b64 v40, v[196:197]
    ds_write_b128 v44, v[176:179] offset:7168
    v_cvt_pk_f16_f32 v180, v132, v133
    v_cvt_pk_f16_f32 v181, v134, v135
    v_cvt_pk_f16_f32 v182, v136, v137
    v_cvt_pk_f16_f32 v183, v138, v139
    v_mfma_f32_32x32x16_bf16 v[92:107], a[192:195], v[188:191], v[92:107]
    ds_write_b128 v44, v[180:183] offset:6144
    v_cvt_pk_f16_f32 v184, v124, v125
    v_cvt_pk_f16_f32 v185, v126, v127
    v_cvt_pk_f16_f32 v186, v128, v129
    v_cvt_pk_f16_f32 v187, v130, v131
    v_mfma_f32_32x32x16_bf16 v[92:107], a[196:199], v[192:195], v[92:107]
    ds_write_b128 v44, v[184:187] offset:5120
    v_cvt_pk_f16_f32 v172, v116, v117
    v_cvt_pk_f16_f32 v173, v118, v119
    v_cvt_pk_f16_f32 v174, v120, v121
    v_cvt_pk_f16_f32 v175, v122, v123
    s_waitcnt lgkmcnt(4)
    v_mfma_f32_32x32x16_bf16 v[76:91], a[200:203], v[188:191], v[76:91]
    ds_write_b128 v44, v[172:175] offset:4096
    v_cvt_pk_f16_f32 v176, v108, v109
    v_cvt_pk_f16_f32 v177, v110, v111
    v_cvt_pk_f16_f32 v178, v112, v113
    v_cvt_pk_f16_f32 v179, v114, v115
    v_mfma_f32_32x32x16_bf16 v[76:91], a[204:207], v[192:195], v[76:91]
    ds_write_b128 v44, v[176:179] offset:3072
    v_cvt_pk_f16_f32 v180, v100, v101
    v_cvt_pk_f16_f32 v181, v102, v103
    v_cvt_pk_f16_f32 v182, v104, v105
    v_cvt_pk_f16_f32 v183, v106, v107
    v_mfma_f32_32x32x16_bf16 v[60:75], a[208:211], v[188:191], v[60:75]
    ds_write_b128 v44, v[180:183] offset:2048
    v_cvt_pk_f16_f32 v184, v92, v93
    v_cvt_pk_f16_f32 v185, v94, v95
    v_cvt_pk_f16_f32 v186, v96, v97
    v_cvt_pk_f16_f32 v187, v98, v99
    v_mfma_f32_32x32x16_bf16 v[60:75], a[212:215], v[192:195], v[60:75]
    ds_write_b128 v44, v[184:187] offset:1024
    v_cvt_pk_f16_f32 v172, v84, v85
    v_cvt_pk_f16_f32 v173, v86, v87
    v_cvt_pk_f16_f32 v174, v88, v89
    v_cvt_pk_f16_f32 v175, v90, v91
    ds_write_b128 v44, v[172:175] offset:0
    s_waitcnt lgkmcnt(0)
    s_barrier
    ds_read_b64 v[198:199], v41
    ds_read_b64 v[200:201], v42
    ds_read_b64 v[202:203], v43
    ds_read_b128 v[84:87], v45 offset:0
    ds_read_b128 v[88:91], v46 offset:0
    ds_read_b128 v[92:95], v47 offset:0
    ds_read_b128 v[96:99], v45 offset:1024
    ds_read_b128 v[100:103], v46 offset:1024
    ds_read_b128 v[104:107], v47 offset:1024
    ds_read_b128 v[108:111], v45 offset:2048
    ds_read_b128 v[112:115], v46 offset:2048
    ds_read_b128 v[116:119], v47 offset:2048
    s_waitcnt lgkmcnt(10)
    v_max3_f32 v7, v196, v198, v200
    s_waitcnt lgkmcnt(9)
    v_max_f32 v7, v7, v202
    v_sub_f32 v196, v196, v7
    v_sub_f32 v198, v198, v7
    v_sub_f32 v200, v200, v7
    v_sub_f32 v202, v202, v7
    v_exp_f32 v196, v196
    v_exp_f32 v198, v198
    v_exp_f32 v200, v200
    v_exp_f32 v202, v202
    v_mul_f32 v8, v196, v197
    v_fmac_f32 v8, v198, v199
    v_fmac_f32 v8, v200, v201
    v_fmac_f32 v8, v202, v203
    v_rcp_f32 v8, v8
    s_nop 0
    v_mul_f32 v204, v196, v8
    v_mul_f32 v205, v198, v8
    v_mul_f32 v206, v200, v8
    v_mul_f32 v207, v202, v8
    v_cvt_pk_f16_f32 v205, v205, v205
    v_cvt_pk_f16_f32 v206, v206, v206
    v_cvt_pk_f16_f32 v207, v207, v207
    s_waitcnt lgkmcnt(8)
    v_pk_mul_f16 v84, v84, v205
    v_pk_mul_f16 v85, v85, v205
    v_pk_mul_f16 v86, v86, v205
    v_pk_mul_f16 v87, v87, v205
    s_waitcnt lgkmcnt(7)
    v_pk_fma_f16 v84, v88, v206, v84
    v_pk_fma_f16 v85, v89, v206, v85
    v_pk_fma_f16 v86, v90, v206, v86
    v_pk_fma_f16 v87, v91, v206, v87
    s_waitcnt lgkmcnt(6)
    v_pk_fma_f16 v84, v92, v207, v84
    v_pk_fma_f16 v85, v93, v207, v85
    v_pk_fma_f16 v86, v94, v207, v86
    v_pk_fma_f16 v87, v95, v207, v87
    v_fma_mix_f32 v60, v60, v204, v84 op_sel_hi:[0,0,1]
    v_fma_mix_f32 v61, v61, v204, v84 op_sel:[0,0,1] op_sel_hi:[0,0,1]
    v_fma_mix_f32 v62, v62, v204, v85 op_sel_hi:[0,0,1]
    v_fma_mix_f32 v63, v63, v204, v85 op_sel:[0,0,1] op_sel_hi:[0,0,1]
    v_fma_mix_f32 v64, v64, v204, v86 op_sel_hi:[0,0,1]
    v_fma_mix_f32 v65, v65, v204, v86 op_sel:[0,0,1] op_sel_hi:[0,0,1]
    v_fma_mix_f32 v66, v66, v204, v87 op_sel_hi:[0,0,1]
    v_fma_mix_f32 v67, v67, v204, v87 op_sel:[0,0,1] op_sel_hi:[0,0,1]
    v_cvt_pk_bf16_f32 v124, v60, v61
    v_cvt_pk_bf16_f32 v125, v62, v63
    v_cvt_pk_bf16_f32 v126, v64, v65
    v_cvt_pk_bf16_f32 v127, v66, v67
    ds_write_b128 v48, v[124:127] offset:0
    s_waitcnt lgkmcnt(6)
    v_pk_mul_f16 v96, v96, v205
    v_pk_mul_f16 v97, v97, v205
    v_pk_mul_f16 v98, v98, v205
    v_pk_mul_f16 v99, v99, v205
    s_waitcnt lgkmcnt(5)
    v_pk_fma_f16 v96, v100, v206, v96
    v_pk_fma_f16 v97, v101, v206, v97
    v_pk_fma_f16 v98, v102, v206, v98
    v_pk_fma_f16 v99, v103, v206, v99
    s_waitcnt lgkmcnt(4)
    v_pk_fma_f16 v96, v104, v207, v96
    v_pk_fma_f16 v97, v105, v207, v97
    v_pk_fma_f16 v98, v106, v207, v98
    v_pk_fma_f16 v99, v107, v207, v99
    v_fma_mix_f32 v68, v68, v204, v96 op_sel_hi:[0,0,1]
    v_fma_mix_f32 v69, v69, v204, v96 op_sel:[0,0,1] op_sel_hi:[0,0,1]
    v_fma_mix_f32 v70, v70, v204, v97 op_sel_hi:[0,0,1]
    v_fma_mix_f32 v71, v71, v204, v97 op_sel:[0,0,1] op_sel_hi:[0,0,1]
    v_fma_mix_f32 v72, v72, v204, v98 op_sel_hi:[0,0,1]
    v_fma_mix_f32 v73, v73, v204, v98 op_sel:[0,0,1] op_sel_hi:[0,0,1]
    v_fma_mix_f32 v74, v74, v204, v99 op_sel_hi:[0,0,1]
    v_fma_mix_f32 v75, v75, v204, v99 op_sel:[0,0,1] op_sel_hi:[0,0,1]
    v_cvt_pk_bf16_f32 v128, v68, v69
    v_cvt_pk_bf16_f32 v129, v70, v71
    v_cvt_pk_bf16_f32 v130, v72, v73
    v_cvt_pk_bf16_f32 v131, v74, v75
    ds_write_b128 v48, v[128:131] offset:1024
    s_waitcnt lgkmcnt(4)
    v_pk_mul_f16 v108, v108, v205
    v_pk_mul_f16 v109, v109, v205
    v_pk_mul_f16 v110, v110, v205
    v_pk_mul_f16 v111, v111, v205
    s_waitcnt lgkmcnt(3)
    v_pk_fma_f16 v108, v112, v206, v108
    v_pk_fma_f16 v109, v113, v206, v109
    v_pk_fma_f16 v110, v114, v206, v110
    v_pk_fma_f16 v111, v115, v206, v111
    s_waitcnt lgkmcnt(2)
    v_pk_fma_f16 v108, v116, v207, v108
    v_pk_fma_f16 v109, v117, v207, v109
    v_pk_fma_f16 v110, v118, v207, v110
    v_pk_fma_f16 v111, v119, v207, v111
    v_fma_mix_f32 v76, v76, v204, v108 op_sel_hi:[0,0,1]
    v_fma_mix_f32 v77, v77, v204, v108 op_sel:[0,0,1] op_sel_hi:[0,0,1]
    v_fma_mix_f32 v78, v78, v204, v109 op_sel_hi:[0,0,1]
    v_fma_mix_f32 v79, v79, v204, v109 op_sel:[0,0,1] op_sel_hi:[0,0,1]
    v_fma_mix_f32 v80, v80, v204, v110 op_sel_hi:[0,0,1]
    v_fma_mix_f32 v81, v81, v204, v110 op_sel:[0,0,1] op_sel_hi:[0,0,1]
    v_fma_mix_f32 v82, v82, v204, v111 op_sel_hi:[0,0,1]
    v_fma_mix_f32 v83, v83, v204, v111 op_sel:[0,0,1] op_sel_hi:[0,0,1]
    v_cvt_pk_bf16_f32 v132, v76, v77
    v_cvt_pk_bf16_f32 v133, v78, v79
    v_cvt_pk_bf16_f32 v134, v80, v81
    v_cvt_pk_bf16_f32 v135, v82, v83
    ds_write_b128 v48, v[132:135] offset:2048
    s_waitcnt lgkmcnt(0)
    s_barrier
    ds_read_b128 a[0:3], v49 offset:0
    ds_read_b128 a[4:7], v49 offset:2048
    ds_read_b128 a[8:11], v49 offset:4096
    ds_read_b128 a[12:15], v49 offset:6144
    ds_read_b128 a[16:19], v49 offset:8192
    ds_read_b128 a[20:23], v49 offset:10240
    ds_read_b128 a[24:27], v49 offset:256
    ds_read_b128 a[28:31], v49 offset:2304
    ds_read_b128 a[32:35], v49 offset:4352
    ds_read_b128 a[36:39], v49 offset:6400
    ds_read_b128 a[40:43], v49 offset:8448
    ds_read_b128 a[44:47], v49 offset:10496
    s_waitcnt vmcnt(17) lgkmcnt(11)
    v_mfma_f32_16x16x32_bf16 v[220:223], a[48:51], a[0:3], v[220:223]
    s_waitcnt vmcnt(11)
    v_mfma_f32_16x16x32_bf16 v[224:227], a[72:75], a[0:3], v[224:227]
    s_waitcnt vmcnt(5)
    v_mfma_f32_16x16x32_bf16 v[228:231], a[96:99], a[0:3], v[228:231]
    s_waitcnt lgkmcnt(10)
    v_mfma_f32_16x16x32_bf16 v[220:223], a[52:55], a[4:7], v[220:223]
    v_mfma_f32_16x16x32_bf16 v[224:227], a[76:79], a[4:7], v[224:227]
    s_waitcnt vmcnt(4)
    v_mfma_f32_16x16x32_bf16 v[228:231], a[100:103], a[4:7], v[228:231]
    s_waitcnt lgkmcnt(9)
    v_mfma_f32_16x16x32_bf16 v[220:223], a[56:59], a[8:11], v[220:223]
    v_mfma_f32_16x16x32_bf16 v[224:227], a[80:83], a[8:11], v[224:227]
    s_waitcnt vmcnt(3)
    v_mfma_f32_16x16x32_bf16 v[228:231], a[104:107], a[8:11], v[228:231]
    s_waitcnt lgkmcnt(8)
    v_mfma_f32_16x16x32_bf16 v[220:223], a[60:63], a[12:15], v[220:223]
    v_mfma_f32_16x16x32_bf16 v[224:227], a[84:87], a[12:15], v[224:227]
    s_waitcnt vmcnt(2)
    v_mfma_f32_16x16x32_bf16 v[228:231], a[108:111], a[12:15], v[228:231]
    s_waitcnt lgkmcnt(7)
    v_mfma_f32_16x16x32_bf16 v[220:223], a[64:67], a[16:19], v[220:223]
    v_mfma_f32_16x16x32_bf16 v[224:227], a[88:91], a[16:19], v[224:227]
    s_waitcnt vmcnt(1)
    v_mfma_f32_16x16x32_bf16 v[228:231], a[112:115], a[16:19], v[228:231]
    s_waitcnt lgkmcnt(6)
    v_mfma_f32_16x16x32_bf16 v[220:223], a[68:71], a[20:23], v[220:223]
    v_mfma_f32_16x16x32_bf16 v[224:227], a[92:95], a[20:23], v[224:227]
    s_waitcnt vmcnt(0)
    v_mfma_f32_16x16x32_bf16 v[228:231], a[116:119], a[20:23], v[228:231]
    s_waitcnt lgkmcnt(5)
    v_mfma_f32_16x16x32_bf16 v[232:235], a[48:51], a[24:27], v[232:235]
    v_mfma_f32_16x16x32_bf16 v[236:239], a[72:75], a[24:27], v[236:239]
    v_mfma_f32_16x16x32_bf16 v[240:243], a[96:99], a[24:27], v[240:243]
    s_waitcnt lgkmcnt(4)
    v_mfma_f32_16x16x32_bf16 v[232:235], a[52:55], a[28:31], v[232:235]
    v_mfma_f32_16x16x32_bf16 v[236:239], a[76:79], a[28:31], v[236:239]
    v_cvt_pk_bf16_f32 v124, v220, v221
    v_mfma_f32_16x16x32_bf16 v[240:243], a[100:103], a[28:31], v[240:243]
    v_cvt_pk_bf16_f32 v125, v222, v223
    s_waitcnt lgkmcnt(3)
    v_mfma_f32_16x16x32_bf16 v[232:235], a[56:59], a[32:35], v[232:235]
    v_cvt_pk_bf16_f32 v126, v224, v225
    v_mfma_f32_16x16x32_bf16 v[236:239], a[80:83], a[32:35], v[236:239]
    v_cvt_pk_bf16_f32 v127, v226, v227
    v_mfma_f32_16x16x32_bf16 v[240:243], a[104:107], a[32:35], v[240:243]
    v_cvt_pk_bf16_f32 v128, v228, v229
    s_waitcnt lgkmcnt(2)
    v_mfma_f32_16x16x32_bf16 v[232:235], a[60:63], a[36:39], v[232:235]
    v_cvt_pk_bf16_f32 v129, v230, v231
    v_mfma_f32_16x16x32_bf16 v[236:239], a[84:87], a[36:39], v[236:239]
    buffer_store_dwordx4 v[124:127], v54, s[20:23], 0 offen
    v_mfma_f32_16x16x32_bf16 v[240:243], a[108:111], a[36:39], v[240:243]
    s_waitcnt lgkmcnt(1)
    v_mfma_f32_16x16x32_bf16 v[232:235], a[64:67], a[40:43], v[232:235]
    v_mfma_f32_16x16x32_bf16 v[236:239], a[88:91], a[40:43], v[236:239]
    buffer_store_dwordx2 v[128:129], v56, s[20:23], 0 offen offset:64
    v_mfma_f32_16x16x32_bf16 v[240:243], a[112:115], a[40:43], v[240:243]
    s_waitcnt lgkmcnt(0)
    v_mfma_f32_16x16x32_bf16 v[232:235], a[68:71], a[44:47], v[232:235]
    v_mfma_f32_16x16x32_bf16 v[236:239], a[92:95], a[44:47], v[236:239]
    v_mfma_f32_16x16x32_bf16 v[240:243], a[116:119], a[44:47], v[240:243]
    s_nop 5
    v_cvt_pk_bf16_f32 v132, v232, v233
    v_cvt_pk_bf16_f32 v133, v234, v235
    v_cvt_pk_bf16_f32 v134, v236, v237
    v_cvt_pk_bf16_f32 v135, v238, v239
    v_cvt_pk_bf16_f32 v136, v240, v241
    v_cvt_pk_bf16_f32 v137, v242, v243
    buffer_store_dwordx4 v[132:135], v55, s[20:23], 0 offen
    buffer_store_dwordx2 v[136:137], v57, s[20:23], 0 offen offset:64
L_fin:
L_exit:
    s_endpgm
L_reset:
    s_cmp_lt_u32 s32, 64
    s_cbranch_scc1 L_exit
    s_sub_u32 s32, s32, 64
    s_waitcnt lgkmcnt(0)
    s_mov_b64 s[12:13], s[52:53]
    s_mov_b64 s[16:17], s[62:63]
    s_mov_b64 s[20:21], s[58:59]
    s_mov_b64 s[24:25], s[60:61]
    s_mov_b32 s14, 73728
    s_mov_b32 s15, 0x20000
    s_mov_b32 s18, 4194304
    s_mov_b32 s19, 0x20000
    s_mov_b32 s22, 1959552
    s_mov_b32 s23, 0x20000
    s_mov_b32 s26, 256
    s_mov_b32 s27, 0x20000
    v_lshrrev_b32 v7, 1, v0
    v_lshlrev_b32 v7, 7, v7
    v_and_b32 v8, 1, v0
    v_lshl_add_u32 v7, v8, 4, v7
    v_lshlrev_b32 v8, 4, v0
    s_lshl_b32 s33, s32, 12
    s_add_u32 s33, s33, 2359296
    s_cmp_eq_u32 s32, 7
    s_cselect_b64 vcc, -1, 0
    s_cselect_b32 s33, 2392064, s33
    s_cselect_b32 s34, 0, 5242880
    v_cndmask_b32 v7, v7, v8, vcc
    v_add_u32 v16, s33, v7
    v_add_u32 v15, s34, v16
    v_mov_b32 v204, 0
    v_mov_b32 v205, 0
    v_mov_b32 v206, 0
    v_mov_b32 v207, 0
    buffer_store_dwordx4 v[204:207], v16, s[16:19], 0 offen sc0 sc1
    buffer_store_dwordx4 v[204:207], v15, s[16:19], 0 offen offset:1024 sc0 sc1
    buffer_store_dwordx4 v[204:207], v15, s[16:19], 0 offen offset:2048 sc0 sc1
    s_lshl_b32 s33, s32, 2
    v_mov_b32 v7, 1
    v_mov_b32 v8, s33
    s_waitcnt vmcnt(0)
    s_mov_b64 exec, 1
    buffer_store_dword v7, v8, s[24:27], 0 offen sc0 sc1
    s_endpgm
L_ab:
    s_lshl_b32 s33, s33, 1
    s_add_u32 s33, s33, s3
    s_sub_u32 s34, s33, 9
    s_min_u32 s35, s33, s34
    s_mul_i32 s36, s35, 86
    s_lshr_b32 s36, s36, 8
    s_mul_i32 s37, s36, 3
    s_sub_u32 s37, s35, s37
    s_and_b32 s34, s32, 1
    s_mul_i32 s34, s34, 3
    s_add_u32 s37, s37, s34
    s_bfe_u32 s34, s32, 0x20001
    s_mul_i32 s35, s34, 18
    s_mul_i32 s38, s36, 6
    s_add_u32 s35, s35, s38
    s_add_u32 s35, s35, s37
    s_mov_b32 s32, s33
    s_mov_b32 s33, s35
    v_and_b32 v7, 15, v0
    v_lshrrev_b32 v8, 4, v0
    v_bfe_u32 v9, v0, 2, 2
    v_and_b32 v10, 3, v0
    v_bfe_u32 v15, v0, 3, 1
    v_bfe_u32 v16, v0, 2, 1
    v_lshlrev_b32 v1, 4, v0
    s_lshl_b32 s38, s37, 5
    s_waitcnt lgkmcnt(0)
    s_mov_b64 s[8:9], s[54:55]
    s_mov_b32 s10, 221184
    s_mov_b32 s11, 0x20000
    s_mov_b64 s[12:13], s[56:57]
    s_mov_b64 s[16:17], s[62:63]
    s_mov_b64 s[20:21], s[58:59]
    s_mov_b64 s[24:25], s[60:61]
    s_mov_b32 s14, 73728
    s_mov_b32 s15, 0x20000
    s_mov_b32 s18, 4194304
    s_mov_b32 s19, 0x20000
    s_mov_b32 s22, 1959552
    s_mov_b32 s23, 0x20000
    s_mov_b32 s26, 256
    s_mov_b32 s27, 0x20000
    s_cmp_ge_u32 s32, 9
    s_cbranch_scc1 L_ab_B
    v_lshl_add_u32 v11, v15, 4, v10
    v_lshl_add_u32 v11, v16, 2, v11
    v_add_u32 v13, s38, v11
    v_mul_u32_u24 v13, 1152, v13
    v_lshl_add_u32 v13, v8, 4, v13
    v_add_u32 v12, 9216, v13
    v_lshl_add_u32 v11, s36, 3, v11
    v_lshl_add_u32 v14, v16, 3, v10
    v_lshl_add_u32 v14, v15, 2, v14
    v_add_u32 v14, 32, v14
    s_cmp_eq_u32 s36, 2
    s_cselect_b64 vcc, -1, 0
    v_cndmask_b32 v11, v11, v14, vcc
    s_mul_i32 s38, s34, 48
    v_add_u32 v11, s38, v11
    v_mul_u32_u24 v11, 1152, v11
    v_lshl_add_u32 v11, v8, 4, v11
    s_mov_b32 s39, 0x3dd53b95
    s_mov_b32 s40, 2162688
    buffer_load_dwordx4 v[60:63], v13, s[8:11], 0 offen offset:0
    buffer_load_dwordx4 v[64:67], v12, s[8:11], 0 offen offset:0
    buffer_load_dwordx4 v[124:127], v11, s[8:11], 0 offen offset:384
    buffer_load_dwordx4 v[68:71], v13, s[8:11], 0 offen offset:64
    buffer_load_dwordx4 v[72:75], v12, s[8:11], 0 offen offset:64
    buffer_load_dwordx4 v[128:131], v11, s[8:11], 0 offen offset:448
    buffer_load_dwordx4 v[76:79], v13, s[8:11], 0 offen offset:128
    buffer_load_dwordx4 v[80:83], v12, s[8:11], 0 offen offset:128
    buffer_load_dwordx4 v[132:135], v11, s[8:11], 0 offen offset:512
    buffer_load_dwordx4 v[84:87], v13, s[8:11], 0 offen offset:192
    buffer_load_dwordx4 v[88:91], v12, s[8:11], 0 offen offset:192
    buffer_load_dwordx4 v[136:139], v11, s[8:11], 0 offen offset:576
    buffer_load_dwordx4 v[92:95], v13, s[8:11], 0 offen offset:256
    buffer_load_dwordx4 v[96:99], v12, s[8:11], 0 offen offset:256
    buffer_load_dwordx4 v[140:143], v11, s[8:11], 0 offen offset:640
    buffer_load_dwordx4 v[100:103], v13, s[8:11], 0 offen offset:320
    buffer_load_dwordx4 v[104:107], v12, s[8:11], 0 offen offset:320
    buffer_load_dwordx4 v[144:147], v11, s[8:11], 0 offen offset:704
    s_waitcnt vmcnt(0)
    s_branch L_ab_mm
L_ab_B:
    v_lshlrev_b32 v11, 2, v0
    s_mov_b64 exec, 0xff
    s_mov_b32 s68, 0
L_pollD3:
    s_sleep 16
    buffer_load_dword v7, v11, s[24:27], 0 offen sc0 sc1
    s_add_u32 s68, s68, 1
    s_cmp_gt_u32 s68, 1048576
    s_waitcnt vmcnt(0)
    s_cbranch_scc1 L_pollD3_out
    v_cmp_ne_u32 vcc, 1, v7
    s_nop 0
    s_and_b64 exec, exec, vcc
    s_cbranch_execnz L_pollD3
L_pollD3_out:
    s_mov_b64 exec, -1
    v_lshl_add_u32 v11, v9, 3, v10
    v_add_u32 v11, s38, v11
    v_mul_u32_u24 v11, 1152, v11
    v_lshl_add_u32 v11, v8, 4, v11
    v_add_u32 v12, 4608, v11
    s_cmp_eq_u32 s36, 2
    s_cselect_b32 s38, 32, 0
    s_mul_i32 s39, s34, 96
    s_add_u32 s38, s38, s39
    v_lshrrev_b32 v13, 2, v0
    v_mul_u32_u24 v13, 384, v13
    v_lshl_add_u32 v13, v10, 4, v13
    v_add_u32 v13, s38, v13
    s_mul_i32 s47, s3, 12288
    s_add_u32 m0, s47, 0
    s_mov_b32 s46, 0
    buffer_load_dwordx4 v13, s[12:15], s46 offen lds
    s_add_u32 m0, s47, 1024
    s_mov_b32 s46, 6144
    buffer_load_dwordx4 v13, s[12:15], s46 offen lds
    s_add_u32 m0, s47, 2048
    s_mov_b32 s46, 12288
    buffer_load_dwordx4 v13, s[12:15], s46 offen lds
    s_add_u32 m0, s47, 3072
    s_mov_b32 s46, 18432
    buffer_load_dwordx4 v13, s[12:15], s46 offen lds
    s_add_u32 m0, s47, 4096
    s_mov_b32 s46, 24576
    buffer_load_dwordx4 v13, s[12:15], s46 offen lds
    s_add_u32 m0, s47, 5120
    s_mov_b32 s46, 30720
    buffer_load_dwordx4 v13, s[12:15], s46 offen lds
    s_add_u32 m0, s47, 6144
    s_mov_b32 s46, 36864
    buffer_load_dwordx4 v13, s[12:15], s46 offen lds
    s_add_u32 m0, s47, 7168
    s_mov_b32 s46, 43008
    buffer_load_dwordx4 v13, s[12:15], s46 offen lds
    s_add_u32 m0, s47, 8192
    s_mov_b32 s46, 49152
    buffer_load_dwordx4 v13, s[12:15], s46 offen lds
    s_add_u32 m0, s47, 9216
    s_mov_b32 s46, 55296
    buffer_load_dwordx4 v13, s[12:15], s46 offen lds
    s_add_u32 m0, s47, 10240
    s_mov_b32 s46, 61440
    buffer_load_dwordx4 v13, s[12:15], s46 offen lds
    s_add_u32 m0, s47, 11264
    s_mov_b32 s46, 67584
    buffer_load_dwordx4 v13, s[12:15], s46 offen lds
    buffer_load_dwordx4 v[60:63], v11, s[8:11], 0 offen offset:768
    buffer_load_dwordx4 v[64:67], v12, s[8:11], 0 offen offset:768
    buffer_load_dwordx4 v[68:71], v11, s[8:11], 0 offen offset:832
    buffer_load_dwordx4 v[72:75], v12, s[8:11], 0 offen offset:832
    buffer_load_dwordx4 v[76:79], v11, s[8:11], 0 offen offset:896
    buffer_load_dwordx4 v[80:83], v12, s[8:11], 0 offen offset:896
    buffer_load_dwordx4 v[84:87], v11, s[8:11], 0 offen offset:960
    buffer_load_dwordx4 v[88:91], v12, s[8:11], 0 offen offset:960
    buffer_load_dwordx4 v[92:95], v11, s[8:11], 0 offen offset:1024
    buffer_load_dwordx4 v[96:99], v12, s[8:11], 0 offen offset:1024
    buffer_load_dwordx4 v[100:103], v11, s[8:11], 0 offen offset:1088
    buffer_load_dwordx4 v[104:107], v12, s[8:11], 0 offen offset:1088
    v_lshl_add_u32 v14, v8, 3, v9
    v_lshlrev_b32 v14, 6, v14
    s_cmp_eq_u32 s36, 2
    s_cselect_b32 s38, 3, 4
    s_cselect_b32 s39, 32, s36
    s_cselect_b32 s40, 0, 3
    s_lshl_b32 s39, s39, s40
    s_add_u32 s39, s39, s47
    v_lshlrev_b32 v15, s38, v10
    v_add3_u32 v14, v14, v15, s39
    s_mov_b32 s39, 1.0
    s_mov_b32 s40, 2236416
    s_waitcnt vmcnt(12)
    ds_read_b64_tr_b16 v[124:125], v14 offset:0
    ds_read_b64_tr_b16 v[126:127], v14 offset:256
    ds_read_b64_tr_b16 v[128:129], v14 offset:2048
    ds_read_b64_tr_b16 v[130:131], v14 offset:2304
    ds_read_b64_tr_b16 v[132:133], v14 offset:4096
    ds_read_b64_tr_b16 v[134:135], v14 offset:4352
    ds_read_b64_tr_b16 v[136:137], v14 offset:6144
    ds_read_b64_tr_b16 v[138:139], v14 offset:6400
    ds_read_b64_tr_b16 v[140:141], v14 offset:8192
    ds_read_b64_tr_b16 v[142:143], v14 offset:8448
    ds_read_b64_tr_b16 v[144:145], v14 offset:10240
    ds_read_b64_tr_b16 v[146:147], v14 offset:10496
    s_waitcnt vmcnt(0) lgkmcnt(0)
L_ab_mm:
    v_mfma_f32_16x16x32_bf16 v[156:159], v[60:63], v[124:127], 0
    v_mfma_f32_16x16x32_bf16 v[160:163], v[64:67], v[124:127], 0
    v_mfma_f32_16x16x32_bf16 v[156:159], v[68:71], v[128:131], v[156:159]
    v_mfma_f32_16x16x32_bf16 v[160:163], v[72:75], v[128:131], v[160:163]
    v_mfma_f32_16x16x32_bf16 v[156:159], v[76:79], v[132:135], v[156:159]
    v_mfma_f32_16x16x32_bf16 v[160:163], v[80:83], v[132:135], v[160:163]
    v_mfma_f32_16x16x32_bf16 v[156:159], v[84:87], v[136:139], v[156:159]
    v_mfma_f32_16x16x32_bf16 v[160:163], v[88:91], v[136:139], v[160:163]
    v_mfma_f32_16x16x32_bf16 v[156:159], v[92:95], v[140:143], v[156:159]
    v_mfma_f32_16x16x32_bf16 v[160:163], v[96:99], v[140:143], v[160:163]
    v_mfma_f32_16x16x32_bf16 v[156:159], v[100:103], v[144:147], v[156:159]
    v_mfma_f32_16x16x32_bf16 v[160:163], v[104:107], v[144:147], v[160:163]
    s_lshl_b32 s33, s33, 10
    s_add_u32 s40, s40, s33
    s_nop 4
    v_mul_f32 v156, s39, v156
    v_mul_f32 v157, s39, v157
    v_mul_f32 v158, s39, v158
    v_mul_f32 v159, s39, v159
    v_mul_f32 v160, s39, v160
    v_mul_f32 v161, s39, v161
    v_mul_f32 v162, s39, v162
    v_mul_f32 v163, s39, v163
    v_cvt_pk_bf16_f32 v164, v156, v157
    v_cvt_pk_bf16_f32 v165, v158, v159
    v_cvt_pk_bf16_f32 v166, v160, v161
    v_cvt_pk_bf16_f32 v167, v162, v163
    buffer_store_dwordx4 v[164:167], v1, s[16:19], s40 offen sc1
    v_lshlrev_b32 v8, 2, v0
    s_mov_b64 exec, 0xff
    s_mov_b32 s68, 0
L_pollD2:
    s_sleep 4
    buffer_load_dword v7, v8, s[24:27], 0 offen sc0 sc1
    s_add_u32 s68, s68, 1
    s_cmp_gt_u32 s68, 1048576
    s_waitcnt vmcnt(0)
    s_cbranch_scc1 L_pollD2_out
    v_cmp_ne_u32 vcc, 1, v7
    s_nop 0
    s_and_b64 exec, exec, vcc
    s_cbranch_execnz L_pollD2
L_pollD2_out:
    s_mov_b64 exec, -1
    s_cmp_ge_u32 s32, 9
    s_cselect_b32 s32, 1152, 0
    s_lshr_b32 s33, s33, 6
    s_add_u32 s32, s32, s33
    s_add_u32 s32, s32, 2392064
    v_mov_b32 v7, 1
    v_mov_b32 v8, s32
    s_mov_b64 exec, 1
    buffer_store_dword v7, v8, s[16:19], 0 offen sc0 sc1
    s_branch L_fin
L_slow0:
    s_call_b64 s[66:67], L_rescale1
    s_branch L_ok0
L_slow1:
    s_call_b64 s[66:67], L_rescale0
    s_branch L_ok1
L_slow2:
    s_call_b64 s[66:67], L_rescale1
    s_branch L_ok2
L_slow3:
    s_call_b64 s[66:67], L_rescale0
    s_branch L_ok3
L_waitA:
    s_cselect_b32 s37, 1, 0
    s_mov_b32 s68, 0
L_waitA1:
    s_sleep 8
    buffer_load_dword v6, v5, s[16:19], 0 offen offset:0 sc0 sc1
    s_add_u32 s68, s68, 1
    s_cmp_gt_u32 s68, 1048576
    s_waitcnt vmcnt(0)
    s_cbranch_scc1 L_waitA2
    v_cmp_ne_u32 vcc, 1, v6
    s_cbranch_vccnz L_waitA1
L_waitA2:
    s_cmp_lg_u32 s37, 0
    s_branch L_haveA
L_waitB:
    s_cselect_b32 s37, 1, 0
    s_mov_b32 s68, 0
L_waitB1:
    s_sleep 8
    buffer_load_dword v6, v5, s[16:19], 0 offen offset:1152 sc0 sc1
    s_add_u32 s68, s68, 1
    s_cmp_gt_u32 s68, 1048576
    s_waitcnt vmcnt(0)
    s_cbranch_scc1 L_waitB2
    v_cmp_ne_u32 vcc, 1, v6
    s_cbranch_vccnz L_waitB1
L_waitB2:
    s_cmp_lg_u32 s37, 0
    s_branch L_haveB
L_rescale0:
    s_nop 15
    v_mov_b32 v7, v219
    s_nop 1
    v_permlane32_swap_b32 v219, v7
    v_max_f32 v7, v219, v7
    v_add_f32 v7, 0x40c00000, v7
    v_max_f32 v7, 0, v7
    v_exp_f32 v8, -v7
    v_add_f32 v216, v216, v7
    v_sub_f32 v156, v156, v7
    v_sub_f32 v157, v157, v7
    v_sub_f32 v158, v158, v7
    v_sub_f32 v159, v159, v7
    v_sub_f32 v160, v160, v7
    v_sub_f32 v161, v161, v7
    v_sub_f32 v162, v162, v7
    v_sub_f32 v163, v163, v7
    v_sub_f32 v164, v164, v7
    v_sub_f32 v165, v165, v7
    v_sub_f32 v166, v166, v7
    v_sub_f32 v167, v167, v7
    v_sub_f32 v168, v168, v7
    v_sub_f32 v169, v169, v7
    v_sub_f32 v170, v170, v7
    v_sub_f32 v171, v171, v7
    v_sub_f32 v188, v188, v7
    v_sub_f32 v189, v189, v7
    v_sub_f32 v190, v190, v7
    v_sub_f32 v191, v191, v7
    v_sub_f32 v192, v192, v7
    v_sub_f32 v193, v193, v7
    v_sub_f32 v194, v194, v7
    v_sub_f32 v195, v195, v7
    v_sub_f32 v196, v196, v7
    v_sub_f32 v197, v197, v7
    v_sub_f32 v198, v198, v7
    v_sub_f32 v199, v199, v7
    v_sub_f32 v200, v200, v7
    v_sub_f32 v201, v201, v7
    v_sub_f32 v202, v202, v7
    v_sub_f32 v203, v203, v7
    v_sub_f32 v204, v204, v7
    v_sub_f32 v205, v205, v7
    v_sub_f32 v206, v206, v7
    v_sub_f32 v207, v207, v7
    v_mul_f32 v217, v217, v8
    v_mul_f32 v218, v218, v8
    v_pk_mul_f32 v[60:61], v[60:61], v[8:9] op_sel_hi:[1,0]
    v_pk_mul_f32 v[62:63], v[62:63], v[8:9] op_sel_hi:[1,0]
    v_pk_mul_f32 v[64:65], v[64:65], v[8:9] op_sel_hi:[1,0]
    v_pk_mul_f32 v[66:67], v[66:67], v[8:9] op_sel_hi:[1,0]
    v_pk_mul_f32 v[68:69], v[68:69], v[8:9] op_sel_hi:[1,0]
    v_pk_mul_f32 v[70:71], v[70:71], v[8:9] op_sel_hi:[1,0]
    v_pk_mul_f32 v[72:73], v[72:73], v[8:9] op_sel_hi:[1,0]
    v_pk_mul_f32 v[74:75], v[74:75], v[8:9] op_sel_hi:[1,0]
    v_pk_mul_f32 v[76:77], v[76:77], v[8:9] op_sel_hi:[1,0]
    v_pk_mul_f32 v[78:79], v[78:79], v[8:9] op_sel_hi:[1,0]
    v_pk_mul_f32 v[80:81], v[80:81], v[8:9] op_sel_hi:[1,0]
    v_pk_mul_f32 v[82:83], v[82:83], v[8:9] op_sel_hi:[1,0]
    v_pk_mul_f32 v[84:85], v[84:85], v[8:9] op_sel_hi:[1,0]
    v_pk_mul_f32 v[86:87], v[86:87], v[8:9] op_sel_hi:[1,0]
    v_pk_mul_f32 v[88:89], v[88:89], v[8:9] op_sel_hi:[1,0]
    v_pk_mul_f32 v[90:91], v[90:91], v[8:9] op_sel_hi:[1,0]
    v_pk_mul_f32 v[92:93], v[92:93], v[8:9] op_sel_hi:[1,0]
    v_pk_mul_f32 v[94:95], v[94:95], v[8:9] op_sel_hi:[1,0]
    v_pk_mul_f32 v[96:97], v[96:97], v[8:9] op_sel_hi:[1,0]
    v_pk_mul_f32 v[98:99], v[98:99], v[8:9] op_sel_hi:[1,0]
    v_pk_mul_f32 v[100:101], v[100:101], v[8:9] op_sel_hi:[1,0]
    v_pk_mul_f32 v[102:103], v[102:103], v[8:9] op_sel_hi:[1,0]
    v_pk_mul_f32 v[104:105], v[104:105], v[8:9] op_sel_hi:[1,0]
    v_pk_mul_f32 v[106:107], v[106:107], v[8:9] op_sel_hi:[1,0]
    v_pk_mul_f32 v[108:109], v[108:109], v[8:9] op_sel_hi:[1,0]
    v_pk_mul_f32 v[110:111], v[110:111], v[8:9] op_sel_hi:[1,0]
    v_pk_mul_f32 v[112:113], v[112:113], v[8:9] op_sel_hi:[1,0]
    v_pk_mul_f32 v[114:115], v[114:115], v[8:9] op_sel_hi:[1,0]
    v_pk_mul_f32 v[116:117], v[116:117], v[8:9] op_sel_hi:[1,0]
    v_pk_mul_f32 v[118:119], v[118:119], v[8:9] op_sel_hi:[1,0]
    v_pk_mul_f32 v[120:121], v[120:121], v[8:9] op_sel_hi:[1,0]
    v_pk_mul_f32 v[122:123], v[122:123], v[8:9] op_sel_hi:[1,0]
    v_pk_mul_f32 v[124:125], v[124:125], v[8:9] op_sel_hi:[1,0]
    v_pk_mul_f32 v[126:127], v[126:127], v[8:9] op_sel_hi:[1,0]
    v_pk_mul_f32 v[128:129], v[128:129], v[8:9] op_sel_hi:[1,0]
    v_pk_mul_f32 v[130:131], v[130:131], v[8:9] op_sel_hi:[1,0]
    v_pk_mul_f32 v[132:133], v[132:133], v[8:9] op_sel_hi:[1,0]
    v_pk_mul_f32 v[134:135], v[134:135], v[8:9] op_sel_hi:[1,0]
    v_pk_mul_f32 v[136:137], v[136:137], v[8:9] op_sel_hi:[1,0]
    v_pk_mul_f32 v[138:139], v[138:139], v[8:9] op_sel_hi:[1,0]
    v_pk_mul_f32 v[140:141], v[140:141], v[8:9] op_sel_hi:[1,0]
    v_pk_mul_f32 v[142:143], v[142:143], v[8:9] op_sel_hi:[1,0]
    v_pk_mul_f32 v[144:145], v[144:145], v[8:9] op_sel_hi:[1,0]
    v_pk_mul_f32 v[146:147], v[146:147], v[8:9] op_sel_hi:[1,0]
    v_pk_mul_f32 v[148:149], v[148:149], v[8:9] op_sel_hi:[1,0]
    v_pk_mul_f32 v[150:151], v[150:151], v[8:9] op_sel_hi:[1,0]
    v_pk_mul_f32 v[152:153], v[152:153], v[8:9] op_sel_hi:[1,0]
    v_pk_mul_f32 v[154:155], v[154:155], v[8:9] op_sel_hi:[1,0]
    s_nop 1
    s_setpc_b64 s[66:67]
L_rescale1:
    s_nop 15
    v_mov_b32 v7, v219
    s_nop 1
    v_permlane32_swap_b32 v219, v7
    v_max_f32 v7, v219, v7
    v_add_f32 v7, 0x40c00000, v7
    v_max_f32 v7, 0, v7
    v_exp_f32 v8, -v7
    v_add_f32 v216, v216, v7
    v_sub_f32 v172, v172, v7
    v_sub_f32 v173, v173, v7
    v_sub_f32 v174, v174, v7
    v_sub_f32 v175, v175, v7
    v_sub_f32 v176, v176, v7
    v_sub_f32 v177, v177, v7
    v_sub_f32 v178, v178, v7
    v_sub_f32 v179, v179, v7
    v_sub_f32 v180, v180, v7
    v_sub_f32 v181, v181, v7
    v_sub_f32 v182, v182, v7
    v_sub_f32 v183, v183, v7
    v_sub_f32 v184, v184, v7
    v_sub_f32 v185, v185, v7
    v_sub_f32 v186, v186, v7
    v_sub_f32 v187, v187, v7
    v_sub_f32 v188, v188, v7
    v_sub_f32 v189, v189, v7
    v_sub_f32 v190, v190, v7
    v_sub_f32 v191, v191, v7
    v_sub_f32 v192, v192, v7
    v_sub_f32 v193, v193, v7
    v_sub_f32 v194, v194, v7
    v_sub_f32 v195, v195, v7
    v_sub_f32 v196, v196, v7
    v_sub_f32 v197, v197, v7
    v_sub_f32 v198, v198, v7
    v_sub_f32 v199, v199, v7
    v_sub_f32 v200, v200, v7
    v_sub_f32 v201, v201, v7
    v_sub_f32 v202, v202, v7
    v_sub_f32 v203, v203, v7
    v_sub_f32 v204, v204, v7
    v_sub_f32 v205, v205, v7
    v_sub_f32 v206, v206, v7
    v_sub_f32 v207, v207, v7
    v_mul_f32 v217, v217, v8
    v_mul_f32 v218, v218, v8
    v_pk_mul_f32 v[60:61], v[60:61], v[8:9] op_sel_hi:[1,0]
    v_pk_mul_f32 v[62:63], v[62:63], v[8:9] op_sel_hi:[1,0]
    v_pk_mul_f32 v[64:65], v[64:65], v[8:9] op_sel_hi:[1,0]
    v_pk_mul_f32 v[66:67], v[66:67], v[8:9] op_sel_hi:[1,0]
    v_pk_mul_f32 v[68:69], v[68:69], v[8:9] op_sel_hi:[1,0]
    v_pk_mul_f32 v[70:71], v[70:71], v[8:9] op_sel_hi:[1,0]
    v_pk_mul_f32 v[72:73], v[72:73], v[8:9] op_sel_hi:[1,0]
    v_pk_mul_f32 v[74:75], v[74:75], v[8:9] op_sel_hi:[1,0]
    v_pk_mul_f32 v[76:77], v[76:77], v[8:9] op_sel_hi:[1,0]
    v_pk_mul_f32 v[78:79], v[78:79], v[8:9] op_sel_hi:[1,0]
    v_pk_mul_f32 v[80:81], v[80:81], v[8:9] op_sel_hi:[1,0]
    v_pk_mul_f32 v[82:83], v[82:83], v[8:9] op_sel_hi:[1,0]
    v_pk_mul_f32 v[84:85], v[84:85], v[8:9] op_sel_hi:[1,0]
    v_pk_mul_f32 v[86:87], v[86:87], v[8:9] op_sel_hi:[1,0]
    v_pk_mul_f32 v[88:89], v[88:89], v[8:9] op_sel_hi:[1,0]
    v_pk_mul_f32 v[90:91], v[90:91], v[8:9] op_sel_hi:[1,0]
    v_pk_mul_f32 v[92:93], v[92:93], v[8:9] op_sel_hi:[1,0]
    v_pk_mul_f32 v[94:95], v[94:95], v[8:9] op_sel_hi:[1,0]
    v_pk_mul_f32 v[96:97], v[96:97], v[8:9] op_sel_hi:[1,0]
    v_pk_mul_f32 v[98:99], v[98:99], v[8:9] op_sel_hi:[1,0]
    v_pk_mul_f32 v[100:101], v[100:101], v[8:9] op_sel_hi:[1,0]
    v_pk_mul_f32 v[102:103], v[102:103], v[8:9] op_sel_hi:[1,0]
    v_pk_mul_f32 v[104:105], v[104:105], v[8:9] op_sel_hi:[1,0]
    v_pk_mul_f32 v[106:107], v[106:107], v[8:9] op_sel_hi:[1,0]
    v_pk_mul_f32 v[108:109], v[108:109], v[8:9] op_sel_hi:[1,0]
    v_pk_mul_f32 v[110:111], v[110:111], v[8:9] op_sel_hi:[1,0]
    v_pk_mul_f32 v[112:113], v[112:113], v[8:9] op_sel_hi:[1,0]
    v_pk_mul_f32 v[114:115], v[114:115], v[8:9] op_sel_hi:[1,0]
    v_pk_mul_f32 v[116:117], v[116:117], v[8:9] op_sel_hi:[1,0]
    v_pk_mul_f32 v[118:119], v[118:119], v[8:9] op_sel_hi:[1,0]
    v_pk_mul_f32 v[120:121], v[120:121], v[8:9] op_sel_hi:[1,0]
    v_pk_mul_f32 v[122:123], v[122:123], v[8:9] op_sel_hi:[1,0]
    v_pk_mul_f32 v[124:125], v[124:125], v[8:9] op_sel_hi:[1,0]
    v_pk_mul_f32 v[126:127], v[126:127], v[8:9] op_sel_hi:[1,0]
    v_pk_mul_f32 v[128:129], v[128:129], v[8:9] op_sel_hi:[1,0]
    v_pk_mul_f32 v[130:131], v[130:131], v[8:9] op_sel_hi:[1,0]
    v_pk_mul_f32 v[132:133], v[132:133], v[8:9] op_sel_hi:[1,0]
    v_pk_mul_f32 v[134:135], v[134:135], v[8:9] op_sel_hi:[1,0]
    v_pk_mul_f32 v[136:137], v[136:137], v[8:9] op_sel_hi:[1,0]
    v_pk_mul_f32 v[138:139], v[138:139], v[8:9] op_sel_hi:[1,0]
    v_pk_mul_f32 v[140:141], v[140:141], v[8:9] op_sel_hi:[1,0]
    v_pk_mul_f32 v[142:143], v[142:143], v[8:9] op_sel_hi:[1,0]
    v_pk_mul_f32 v[144:145], v[144:145], v[8:9] op_sel_hi:[1,0]
    v_pk_mul_f32 v[146:147], v[146:147], v[8:9] op_sel_hi:[1,0]
    v_pk_mul_f32 v[148:149], v[148:149], v[8:9] op_sel_hi:[1,0]
    v_pk_mul_f32 v[150:151], v[150:151], v[8:9] op_sel_hi:[1,0]
    v_pk_mul_f32 v[152:153], v[152:153], v[8:9] op_sel_hi:[1,0]
    v_pk_mul_f32 v[154:155], v[154:155], v[8:9] op_sel_hi:[1,0]
    s_nop 1
    s_setpc_b64 s[66:67]
L_slow4:
    s_nop 15
    v_mov_b32 v7, v219
    s_nop 1
    v_permlane32_swap_b32 v219, v7
    v_max_f32 v7, v219, v7
    v_add_f32 v7, 0x40c00000, v7
    v_max_f32 v7, 0, v7
    v_exp_f32 v8, -v7
    v_add_f32 v216, v216, v7
    v_sub_f32 v172, v172, v7
    v_sub_f32 v173, v173, v7
    v_sub_f32 v174, v174, v7
    v_sub_f32 v175, v175, v7
    v_sub_f32 v176, v176, v7
    v_sub_f32 v177, v177, v7
    v_sub_f32 v178, v178, v7
    v_sub_f32 v179, v179, v7
    v_sub_f32 v180, v180, v7
    v_sub_f32 v181, v181, v7
    v_sub_f32 v182, v182, v7
    v_sub_f32 v183, v183, v7
    v_sub_f32 v184, v184, v7
    v_sub_f32 v185, v185, v7
    v_sub_f32 v186, v186, v7
    v_sub_f32 v187, v187, v7
    v_exp_f32 v156, v172
    v_exp_f32 v157, v173
    v_exp_f32 v158, v174
    v_exp_f32 v159, v175
    v_exp_f32 v160, v176
    v_exp_f32 v161, v177
    v_exp_f32 v162, v178
    v_exp_f32 v163, v179
    v_exp_f32 v164, v180
    v_exp_f32 v165, v181
    v_exp_f32 v166, v182
    v_exp_f32 v167, v183
    v_exp_f32 v168, v184
    v_exp_f32 v169, v185
    v_exp_f32 v170, v186
    v_exp_f32 v171, v187
    v_cvt_pk_bf16_f32 v188, v156, v157
    v_cvt_pk_bf16_f32 v189, v158, v159
    v_cvt_pk_bf16_f32 v190, v160, v161
    v_cvt_pk_bf16_f32 v191, v162, v163
    v_cvt_pk_bf16_f32 v192, v164, v165
    v_cvt_pk_bf16_f32 v193, v166, v167
    v_cvt_pk_bf16_f32 v194, v168, v169
    v_cvt_pk_bf16_f32 v195, v170, v171
    v_mul_f32 v217, v217, v8
    v_mul_f32 v218, v218, v8
    v_pk_mul_f32 v[60:61], v[60:61], v[8:9] op_sel_hi:[1,0]
    v_pk_mul_f32 v[62:63], v[62:63], v[8:9] op_sel_hi:[1,0]
    v_pk_mul_f32 v[64:65], v[64:65], v[8:9] op_sel_hi:[1,0]
    v_pk_mul_f32 v[66:67], v[66:67], v[8:9] op_sel_hi:[1,0]
    v_pk_mul_f32 v[68:69], v[68:69], v[8:9] op_sel_hi:[1,0]
    v_pk_mul_f32 v[70:71], v[70:71], v[8:9] op_sel_hi:[1,0]
    v_pk_mul_f32 v[72:73], v[72:73], v[8:9] op_sel_hi:[1,0]
    v_pk_mul_f32 v[74:75], v[74:75], v[8:9] op_sel_hi:[1,0]
    v_pk_mul_f32 v[76:77], v[76:77], v[8:9] op_sel_hi:[1,0]
    v_pk_mul_f32 v[78:79], v[78:79], v[8:9] op_sel_hi:[1,0]
    v_pk_mul_f32 v[80:81], v[80:81], v[8:9] op_sel_hi:[1,0]
    v_pk_mul_f32 v[82:83], v[82:83], v[8:9] op_sel_hi:[1,0]
    v_pk_mul_f32 v[84:85], v[84:85], v[8:9] op_sel_hi:[1,0]
    v_pk_mul_f32 v[86:87], v[86:87], v[8:9] op_sel_hi:[1,0]
    v_pk_mul_f32 v[88:89], v[88:89], v[8:9] op_sel_hi:[1,0]
    v_pk_mul_f32 v[90:91], v[90:91], v[8:9] op_sel_hi:[1,0]
    v_pk_mul_f32 v[92:93], v[92:93], v[8:9] op_sel_hi:[1,0]
    v_pk_mul_f32 v[94:95], v[94:95], v[8:9] op_sel_hi:[1,0]
    v_pk_mul_f32 v[96:97], v[96:97], v[8:9] op_sel_hi:[1,0]
    v_pk_mul_f32 v[98:99], v[98:99], v[8:9] op_sel_hi:[1,0]
    v_pk_mul_f32 v[100:101], v[100:101], v[8:9] op_sel_hi:[1,0]
    v_pk_mul_f32 v[102:103], v[102:103], v[8:9] op_sel_hi:[1,0]
    v_pk_mul_f32 v[104:105], v[104:105], v[8:9] op_sel_hi:[1,0]
    v_pk_mul_f32 v[106:107], v[106:107], v[8:9] op_sel_hi:[1,0]
    v_pk_mul_f32 v[108:109], v[108:109], v[8:9] op_sel_hi:[1,0]
    v_pk_mul_f32 v[110:111], v[110:111], v[8:9] op_sel_hi:[1,0]
    v_pk_mul_f32 v[112:113], v[112:113], v[8:9] op_sel_hi:[1,0]
    v_pk_mul_f32 v[114:115], v[114:115], v[8:9] op_sel_hi:[1,0]
    v_pk_mul_f32 v[116:117], v[116:117], v[8:9] op_sel_hi:[1,0]
    v_pk_mul_f32 v[118:119], v[118:119], v[8:9] op_sel_hi:[1,0]
    v_pk_mul_f32 v[120:121], v[120:121], v[8:9] op_sel_hi:[1,0]
    v_pk_mul_f32 v[122:123], v[122:123], v[8:9] op_sel_hi:[1,0]
    v_pk_mul_f32 v[124:125], v[124:125], v[8:9] op_sel_hi:[1,0]
    v_pk_mul_f32 v[126:127], v[126:127], v[8:9] op_sel_hi:[1,0]
    v_pk_mul_f32 v[128:129], v[128:129], v[8:9] op_sel_hi:[1,0]
    v_pk_mul_f32 v[130:131], v[130:131], v[8:9] op_sel_hi:[1,0]
    v_pk_mul_f32 v[132:133], v[132:133], v[8:9] op_sel_hi:[1,0]
    v_pk_mul_f32 v[134:135], v[134:135], v[8:9] op_sel_hi:[1,0]
    v_pk_mul_f32 v[136:137], v[136:137], v[8:9] op_sel_hi:[1,0]
    v_pk_mul_f32 v[138:139], v[138:139], v[8:9] op_sel_hi:[1,0]
    v_pk_mul_f32 v[140:141], v[140:141], v[8:9] op_sel_hi:[1,0]
    v_pk_mul_f32 v[142:143], v[142:143], v[8:9] op_sel_hi:[1,0]
    v_pk_mul_f32 v[144:145], v[144:145], v[8:9] op_sel_hi:[1,0]
    v_pk_mul_f32 v[146:147], v[146:147], v[8:9] op_sel_hi:[1,0]
    v_pk_mul_f32 v[148:149], v[148:149], v[8:9] op_sel_hi:[1,0]
    v_pk_mul_f32 v[150:151], v[150:151], v[8:9] op_sel_hi:[1,0]
    v_pk_mul_f32 v[152:153], v[152:153], v[8:9] op_sel_hi:[1,0]
    v_pk_mul_f32 v[154:155], v[154:155], v[8:9] op_sel_hi:[1,0]
    s_nop 1
    s_branch L_ok4
L_codeend:
    s_endpgm
.section .rodata,"a"
.p2align 6
.amdhsa_kernel standalone__video_timesformer__vision_kernel
  .amdhsa_next_free_vgpr 512
  .amdhsa_next_free_sgpr 102
  .amdhsa_accum_offset 256
  .amdhsa_group_segment_fixed_size 0
  .amdhsa_kernarg_size 64
  .amdhsa_user_sgpr_count 2
  .amdhsa_user_sgpr_kernarg_segment_ptr 1
  .amdhsa_system_sgpr_workgroup_id_x 1
  .amdhsa_float_denorm_mode_32 3
.end_amdhsa_kernel
```
